```python
import torch

def _softmax(x, axis=-1):
    return torch.softmax(x, dim=axis)
def _gelu(x):
    return torch.nn.functional.gelu(x, approximate="tanh")
def _silu(x):
    return torch.nn.functional.silu(x)
def _sigmoid(x):
    return torch.sigmoid(x)
def _layernorm(x, axis=-1, eps=1e-5):
    m = x.mean(dim=axis, keepdim=True)
    v = x.var(dim=axis, keepdim=True, unbiased=False)
    return (x - m) / torch.sqrt(v + eps)
def _scatter_add(tgt, idx, src, axis=0):
    return tgt.clone().index_add_(axis, idx, src)
def _segment_sum(src, seg, n):
    out = torch.zeros((n,) + src.shape[1:], dtype=src.dtype)
    return out.index_add_(0, seg, src)
def _pad(x, pw):
    flat = tuple(v for pair in reversed(pw) for v in pair)
    return torch.nn.functional.pad(x, flat)

kernel_name = 'concat_heads__ssm_conv_s4d__spectral_gfnet__prompt'

def setup_inputs():

    _w = (lambda a: (lambda t: t.to(torch.bfloat16) if t.is_floating_point() else t)(torch.as_tensor(a)))
    def _A_setup():
        Bsz, L, D, N = 1, 2048, 640, 128
        return {
            "u": _w((lambda *s: torch.randn(*s, dtype=torch.bfloat16) * 0.05)(Bsz, L, D)),
            "log_A_real": _w((lambda *s: torch.randn(*s, dtype=torch.bfloat16) * 6.4)(D, N) * 0.5),
            "A_imag": _w((lambda *s: torch.randn(*s, dtype=torch.bfloat16) * 0.05)(D, N) * 3.14),
            "C_real": _w((lambda *s: torch.randn(*s, dtype=torch.bfloat16) * 0.05)(D, N) / N ** 0.5),
            "C_imag": _w((lambda *s: torch.randn(*s, dtype=torch.bfloat16) * 0.05)(D, N) / N ** 0.5),
            "log_dt": _w((lambda *s: torch.randn(*s, dtype=torch.bfloat16) * 0.05)(D) * 0.5 - 4.0),
            "D_skip": _w((lambda *s: torch.randn(*s, dtype=torch.bfloat16) * 0.05)(D)),
        }
    _A_in = _A_setup()

    def _B_setup():
        B, S, D = 1, 2048, 640
        Df = D // 2 + 1
        return {
            "x": _w((lambda *s: torch.randn(*s, dtype=torch.bfloat16) * 0.05)(B, S, D)),
            "w_r": _w((lambda *s: torch.randn(*s, dtype=torch.bfloat16) * 0.8)(S, Df) * 0.02),
            "w_i": _w((lambda *s: torch.randn(*s, dtype=torch.bfloat16) * 0.8)(S, Df) * 0.02),
        }
    _B_in = _B_setup()

    return {
        "A_u": _A_in["u"],
        "A_log_A_real": _A_in["log_A_real"],
        "A_A_imag": _A_in["A_imag"],
        "A_C_real": _A_in["C_real"],
        "A_C_imag": _A_in["C_imag"],
        "A_log_dt": _A_in["log_dt"],
        "A_D_skip": _A_in["D_skip"],
        "B_x": _B_in["x"],
        "B_w_r": _B_in["w_r"],
        "B_w_i": _B_in["w_i"],
    }

def reference(A_u, A_log_A_real, A_A_imag, A_C_real, A_C_imag, A_log_dt, A_D_skip, B_x, B_w_r, B_w_i):
    def _A_ref(u, log_A_real, A_imag, C_real, C_imag, log_dt, D_skip):
        L = u.shape[1]
        dt = torch.exp(log_dt)
        A = -torch.exp(log_A_real) + 1j * A_imag
        C = (C_real + 1j * C_imag) * dt[:, None]
        pos = (lambda x, dt: x.to(dt))(torch.arange(L), log_dt.dtype)
        P = torch.exp((A * dt[:, None])[:, :, None] * pos[None, None, :])
        K = 2.0 * torch.einsum("dn,dnl->dl", C, P).real
        L2 = 2 * L
        u_t = (lambda x, *d: x.permute(*d))(u, 0, 2, 1)
        Kf = (lambda x, *a, **k: torch.fft.rfft(x.float(), *a, **k))(K, L2)
        Uf = (lambda x, *a, **k: torch.fft.rfft(x.float(), *a, **k))(u_t, L2)
        y = (lambda x, *a, **k: torch.fft.irfft(x, *a, **k).to(torch.bfloat16))(Uf * Kf[None, :, :], L2)[:, :, :L]
        y = (lambda x, *d: x.permute(*d))(y, 0, 2, 1)
        return y + u * D_skip[None, None, :]

    def _B_ref(x, w_r, w_i):
        B, S, D = x.shape
        X = (lambda x, axes=(-2,-1): torch.fft.rfft2(x.float(), dim=axes))(x, axes=(-2, -1))
        W = w_r + 1j * w_i
        X = X * W
        y = (lambda x, s, axes=(-2,-1): torch.fft.irfft2(x, s=s, dim=axes).to(torch.bfloat16))(X, (S, D), axes=(-2, -1))
        return y

    a = _A_ref(A_u, A_log_A_real, A_A_imag, A_C_real, A_C_imag, A_log_dt, A_D_skip)
    b = _B_ref(B_x, B_w_r, B_w_i)
    return torch.concatenate([a, b], axis=-1)
```

```asm
; @launch kernel=k1_kernel grid=(818,1,1) block=(256,1,1) lds=34816
; @launch kernel=k2_kernel grid=(488,1,1) block=(256,1,1) lds=42784
; @launch kernel=k3_kernel grid=(416,1,1) block=(256,1,1) lds=49152
.amdgcn_target "amdgcn-amd-amdhsa--gfx950"
.text
.globl k1_kernel
.p2align 8
.type k1_kernel,@function
k1_kernel:
s_load_dwordx16 s[16:31], s[0:1], 0
s_load_dwordx8 s[32:39], s[0:1], 64
s_load_dwordx2 s[40:41], s[0:1], 96
s_waitcnt lgkmcnt(0)
s_cmp_lt_u32 s2, 320
s_cbranch_scc1 k1_kernel_KG
s_cmp_lt_u32 s2, 576
s_cbranch_scc1 k1_kernel_P1
s_cmp_lt_u32 s2, 736
s_cbranch_scc1 k1_kernel_UT
s_cmp_lt_u32 s2, 737
s_cbranch_scc1 k1_kernel_TB
s_cmp_lt_u32 s2, 818
s_cbranch_scc1 k1_kernel_PF
s_endpgm
k1_kernel_KG:
s_sub_u32 s3, s2, 0
s_mov_b32 s44, s18
s_mov_b32 s45, s19
s_and_b32 s45, s45, 0xffff
s_mov_b32 s46, 0x28000
s_mov_b32 s47, 0x20000
s_mov_b32 s48, s20
s_mov_b32 s49, s21
s_and_b32 s49, s49, 0xffff
s_mov_b32 s50, 0x28000
s_mov_b32 s51, 0x20000
s_mov_b32 s52, s22
s_mov_b32 s53, s23
s_and_b32 s53, s53, 0xffff
s_mov_b32 s54, 0x28000
s_mov_b32 s55, 0x20000
s_mov_b32 s56, s24
s_mov_b32 s57, s25
s_and_b32 s57, s57, 0xffff
s_mov_b32 s58, 0x28000
s_mov_b32 s59, 0x20000
s_mov_b32 s64, s26
s_mov_b32 s65, s27
s_and_b32 s65, s65, 0xffff
s_mov_b32 s66, 0x500
s_mov_b32 s67, 0x20000
s_add_u32 s68, s40, 0xc00000
s_addc_u32 s69, s41, 0
s_and_b32 s69, s69, 0xffff
s_mov_b32 s70, 0x168000
s_mov_b32 s71, 0x20000
v_and_b32 v1, 63, v0
v_lshrrev_b32 v4, 6, v0
s_nop 0
v_readfirstlane_b32 s60, v4
s_lshl_b32 s72, s3, 1
s_nop 2
s_lshr_b32 s73, s60, 1
s_add_u32 s72, s72, s73
s_and_b32 s73, s60, 1
s_lshl_b32 s74, s72, 8
s_lshl_b32 s75, s73, 7
s_add_u32 s74, s74, s75
v_lshlrev_b32 v5, 1, v1
buffer_load_ushort v8, v5, s[44:47], s74 offen
buffer_load_ushort v9, v5, s[48:51], s74 offen
buffer_load_ushort v10, v5, s[52:55], s74 offen
buffer_load_ushort v11, v5, s[56:59], s74 offen
s_lshl_b32 s75, s72, 1
v_mov_b32 v6, 0
buffer_load_ushort v12, v6, s[64:67], s75 offen
s_mov_b32 s84, s28
s_mov_b32 s85, s29
s_and_b32 s85, s85, 0xffff
s_mov_b32 s86, 0x500
s_mov_b32 s87, 0x20000
buffer_load_ushort v30, v6, s[84:87], s75 offen
s_mul_i32 s76, s60, 8704
v_lshlrev_b32 v2, 2, v1
v_add_u32 v2, s76, v2
v_and_b32 v3, 31, v1
v_lshrrev_b32 v4, 5, v1
v_mul_u32_u24 v7, 272, v3
v_lshlrev_b32 v13, 4, v4
v_add_u32 v7, v7, v13
v_add_u32 v7, s76, v7
s_waitcnt vmcnt(1)
v_lshlrev_b32 v12, 16, v12
v_lshlrev_b32 v8, 16, v8
v_mul_f32 v12, 0x3fb8aa3b, v12
v_mul_f32 v8, 0x3fb8aa3b, v8
v_exp_f32 v12, v12
v_exp_f32 v8, v8
v_cvt_pk_bf16_f32 v12, v12, v12
v_cvt_pk_bf16_f32 v8, v8, v8
v_lshlrev_b32 v12, 16, v12
v_lshlrev_b32 v9, 16, v9
v_lshlrev_b32 v8, 16, v8
v_mul_f32 v9, v9, v12
v_mul_f32 v8, v8, v12
v_add_f32 v12, v12, v12
v_lshlrev_b32 v11, 16, v11
v_mul_f32 v9, 0x3e22f983, v9
v_lshlrev_b32 v10, 16, v10
v_mul_f32 v15, v11, v12
v_mul_f32 v8, 0xbfb8aa3b, v8
v_mul_f32 v11, 0x41000000, v9
v_mul_f32 v14, v10, v12
v_mul_f32 v10, 0x41000000, v8
v_fract_f32 v11, v11
v_exp_f32 v10, v10
v_cos_f32 v18, v11
v_sin_f32 v19, v11
v_mul_f32 v18, v18, v10
v_mul_f32 v19, v19, v10
v_mov_b32 v26, 0x3f80
v_pk_mul_f32 v[22:23], v[18:19], v[18:19] op_sel:[0,0] op_sel_hi:[0,1]
ds_write_b32 v2, v26
v_pk_fma_f32 v[22:23], v[18:19], v[18:19], v[22:23] op_sel:[1,1,0] op_sel_hi:[1,0,1] neg_lo:[0,1,0]
v_cvt_pk_bf16_f32 v27, v18, v19
v_pk_mul_f32 v[24:25], v[22:23], v[18:19] op_sel:[0,0] op_sel_hi:[0,1]
v_cvt_pk_bf16_f32 v28, v22, v23
v_pk_fma_f32 v[24:25], v[22:23], v[18:19], v[24:25] op_sel:[1,1,0] op_sel_hi:[1,0,1] neg_lo:[0,1,0]
ds_write_b32 v2, v27 offset:272
v_pk_mul_f32 v[22:23], v[24:25], v[18:19] op_sel:[0,0] op_sel_hi:[0,1]
v_cvt_pk_bf16_f32 v29, v24, v25
v_pk_fma_f32 v[22:23], v[24:25], v[18:19], v[22:23] op_sel:[1,1,0] op_sel_hi:[1,0,1] neg_lo:[0,1,0]
ds_write_b32 v2, v28 offset:544
v_pk_mul_f32 v[24:25], v[22:23], v[18:19] op_sel:[0,0] op_sel_hi:[0,1]
v_cvt_pk_bf16_f32 v26, v22, v23
v_pk_fma_f32 v[24:25], v[22:23], v[18:19], v[24:25] op_sel:[1,1,0] op_sel_hi:[1,0,1] neg_lo:[0,1,0]
ds_write_b32 v2, v29 offset:816
v_pk_mul_f32 v[22:23], v[24:25], v[18:19] op_sel:[0,0] op_sel_hi:[0,1]
v_cvt_pk_bf16_f32 v27, v24, v25
v_pk_fma_f32 v[22:23], v[24:25], v[18:19], v[22:23] op_sel:[1,1,0] op_sel_hi:[1,0,1] neg_lo:[0,1,0]
ds_write_b32 v2, v26 offset:1088
v_pk_mul_f32 v[24:25], v[22:23], v[18:19] op_sel:[0,0] op_sel_hi:[0,1]
v_cvt_pk_bf16_f32 v28, v22, v23
v_pk_fma_f32 v[24:25], v[22:23], v[18:19], v[24:25] op_sel:[1,1,0] op_sel_hi:[1,0,1] neg_lo:[0,1,0]
ds_write_b32 v2, v27 offset:1360
v_pk_mul_f32 v[22:23], v[24:25], v[18:19] op_sel:[0,0] op_sel_hi:[0,1]
v_cvt_pk_bf16_f32 v29, v24, v25
v_pk_fma_f32 v[22:23], v[24:25], v[18:19], v[22:23] op_sel:[1,1,0] op_sel_hi:[1,0,1] neg_lo:[0,1,0]
ds_write_b32 v2, v28 offset:1632
v_pk_mul_f32 v[24:25], v[22:23], v[18:19] op_sel:[0,0] op_sel_hi:[0,1]
v_cvt_pk_bf16_f32 v26, v22, v23
v_pk_fma_f32 v[24:25], v[22:23], v[18:19], v[24:25] op_sel:[1,1,0] op_sel_hi:[1,0,1] neg_lo:[0,1,0]
ds_write_b32 v2, v29 offset:1904
v_pk_mul_f32 v[22:23], v[24:25], v[18:19] op_sel:[0,0] op_sel_hi:[0,1]
v_cvt_pk_bf16_f32 v27, v24, v25
v_pk_fma_f32 v[22:23], v[24:25], v[18:19], v[22:23] op_sel:[1,1,0] op_sel_hi:[1,0,1] neg_lo:[0,1,0]
ds_write_b32 v2, v26 offset:2176
v_pk_mul_f32 v[24:25], v[22:23], v[18:19] op_sel:[0,0] op_sel_hi:[0,1]
v_cvt_pk_bf16_f32 v28, v22, v23
v_pk_fma_f32 v[24:25], v[22:23], v[18:19], v[24:25] op_sel:[1,1,0] op_sel_hi:[1,0,1] neg_lo:[0,1,0]
ds_write_b32 v2, v27 offset:2448
v_pk_mul_f32 v[22:23], v[24:25], v[18:19] op_sel:[0,0] op_sel_hi:[0,1]
v_cvt_pk_bf16_f32 v29, v24, v25
v_pk_fma_f32 v[22:23], v[24:25], v[18:19], v[22:23] op_sel:[1,1,0] op_sel_hi:[1,0,1] neg_lo:[0,1,0]
ds_write_b32 v2, v28 offset:2720
v_pk_mul_f32 v[24:25], v[22:23], v[18:19] op_sel:[0,0] op_sel_hi:[0,1]
v_cvt_pk_bf16_f32 v26, v22, v23
v_pk_fma_f32 v[24:25], v[22:23], v[18:19], v[24:25] op_sel:[1,1,0] op_sel_hi:[1,0,1] neg_lo:[0,1,0]
ds_write_b32 v2, v29 offset:2992
v_pk_mul_f32 v[22:23], v[24:25], v[18:19] op_sel:[0,0] op_sel_hi:[0,1]
v_cvt_pk_bf16_f32 v27, v24, v25
v_pk_fma_f32 v[22:23], v[24:25], v[18:19], v[22:23] op_sel:[1,1,0] op_sel_hi:[1,0,1] neg_lo:[0,1,0]
ds_write_b32 v2, v26 offset:3264
v_pk_mul_f32 v[24:25], v[22:23], v[18:19] op_sel:[0,0] op_sel_hi:[0,1]
v_cvt_pk_bf16_f32 v28, v22, v23
v_pk_fma_f32 v[24:25], v[22:23], v[18:19], v[24:25] op_sel:[1,1,0] op_sel_hi:[1,0,1] neg_lo:[0,1,0]
ds_write_b32 v2, v27 offset:3536
v_pk_mul_f32 v[22:23], v[24:25], v[18:19] op_sel:[0,0] op_sel_hi:[0,1]
v_cvt_pk_bf16_f32 v29, v24, v25
v_pk_fma_f32 v[22:23], v[24:25], v[18:19], v[22:23] op_sel:[1,1,0] op_sel_hi:[1,0,1] neg_lo:[0,1,0]
ds_write_b32 v2, v28 offset:3808
v_pk_mul_f32 v[24:25], v[22:23], v[18:19] op_sel:[0,0] op_sel_hi:[0,1]
v_cvt_pk_bf16_f32 v26, v22, v23
v_pk_fma_f32 v[24:25], v[22:23], v[18:19], v[24:25] op_sel:[1,1,0] op_sel_hi:[1,0,1] neg_lo:[0,1,0]
ds_write_b32 v2, v29 offset:4080
v_pk_mul_f32 v[22:23], v[24:25], v[18:19] op_sel:[0,0] op_sel_hi:[0,1]
v_cvt_pk_bf16_f32 v27, v24, v25
v_pk_fma_f32 v[22:23], v[24:25], v[18:19], v[22:23] op_sel:[1,1,0] op_sel_hi:[1,0,1] neg_lo:[0,1,0]
ds_write_b32 v2, v26 offset:4352
v_pk_mul_f32 v[24:25], v[22:23], v[18:19] op_sel:[0,0] op_sel_hi:[0,1]
v_cvt_pk_bf16_f32 v28, v22, v23
v_pk_fma_f32 v[24:25], v[22:23], v[18:19], v[24:25] op_sel:[1,1,0] op_sel_hi:[1,0,1] neg_lo:[0,1,0]
ds_write_b32 v2, v27 offset:4624
v_pk_mul_f32 v[22:23], v[24:25], v[18:19] op_sel:[0,0] op_sel_hi:[0,1]
v_cvt_pk_bf16_f32 v29, v24, v25
v_pk_fma_f32 v[22:23], v[24:25], v[18:19], v[22:23] op_sel:[1,1,0] op_sel_hi:[1,0,1] neg_lo:[0,1,0]
ds_write_b32 v2, v28 offset:4896
v_pk_mul_f32 v[24:25], v[22:23], v[18:19] op_sel:[0,0] op_sel_hi:[0,1]
v_cvt_pk_bf16_f32 v26, v22, v23
v_pk_fma_f32 v[24:25], v[22:23], v[18:19], v[24:25] op_sel:[1,1,0] op_sel_hi:[1,0,1] neg_lo:[0,1,0]
ds_write_b32 v2, v29 offset:5168
v_pk_mul_f32 v[22:23], v[24:25], v[18:19] op_sel:[0,0] op_sel_hi:[0,1]
v_cvt_pk_bf16_f32 v27, v24, v25
v_pk_fma_f32 v[22:23], v[24:25], v[18:19], v[22:23] op_sel:[1,1,0] op_sel_hi:[1,0,1] neg_lo:[0,1,0]
ds_write_b32 v2, v26 offset:5440
v_pk_mul_f32 v[24:25], v[22:23], v[18:19] op_sel:[0,0] op_sel_hi:[0,1]
v_cvt_pk_bf16_f32 v28, v22, v23
v_pk_fma_f32 v[24:25], v[22:23], v[18:19], v[24:25] op_sel:[1,1,0] op_sel_hi:[1,0,1] neg_lo:[0,1,0]
ds_write_b32 v2, v27 offset:5712
v_pk_mul_f32 v[22:23], v[24:25], v[18:19] op_sel:[0,0] op_sel_hi:[0,1]
v_cvt_pk_bf16_f32 v29, v24, v25
v_pk_fma_f32 v[22:23], v[24:25], v[18:19], v[22:23] op_sel:[1,1,0] op_sel_hi:[1,0,1] neg_lo:[0,1,0]
ds_write_b32 v2, v28 offset:5984
v_pk_mul_f32 v[24:25], v[22:23], v[18:19] op_sel:[0,0] op_sel_hi:[0,1]
v_cvt_pk_bf16_f32 v26, v22, v23
v_pk_fma_f32 v[24:25], v[22:23], v[18:19], v[24:25] op_sel:[1,1,0] op_sel_hi:[1,0,1] neg_lo:[0,1,0]
ds_write_b32 v2, v29 offset:6256
v_pk_mul_f32 v[22:23], v[24:25], v[18:19] op_sel:[0,0] op_sel_hi:[0,1]
v_cvt_pk_bf16_f32 v27, v24, v25
v_pk_fma_f32 v[22:23], v[24:25], v[18:19], v[22:23] op_sel:[1,1,0] op_sel_hi:[1,0,1] neg_lo:[0,1,0]
ds_write_b32 v2, v26 offset:6528
v_pk_mul_f32 v[24:25], v[22:23], v[18:19] op_sel:[0,0] op_sel_hi:[0,1]
v_cvt_pk_bf16_f32 v28, v22, v23
v_pk_fma_f32 v[24:25], v[22:23], v[18:19], v[24:25] op_sel:[1,1,0] op_sel_hi:[1,0,1] neg_lo:[0,1,0]
ds_write_b32 v2, v27 offset:6800
v_pk_mul_f32 v[22:23], v[24:25], v[18:19] op_sel:[0,0] op_sel_hi:[0,1]
v_cvt_pk_bf16_f32 v29, v24, v25
v_pk_fma_f32 v[22:23], v[24:25], v[18:19], v[22:23] op_sel:[1,1,0] op_sel_hi:[1,0,1] neg_lo:[0,1,0]
ds_write_b32 v2, v28 offset:7072
v_pk_mul_f32 v[24:25], v[22:23], v[18:19] op_sel:[0,0] op_sel_hi:[0,1]
v_cvt_pk_bf16_f32 v26, v22, v23
v_pk_fma_f32 v[24:25], v[22:23], v[18:19], v[24:25] op_sel:[1,1,0] op_sel_hi:[1,0,1] neg_lo:[0,1,0]
ds_write_b32 v2, v29 offset:7344
v_pk_mul_f32 v[22:23], v[24:25], v[18:19] op_sel:[0,0] op_sel_hi:[0,1]
v_cvt_pk_bf16_f32 v27, v24, v25
v_pk_fma_f32 v[22:23], v[24:25], v[18:19], v[22:23] op_sel:[1,1,0] op_sel_hi:[1,0,1] neg_lo:[0,1,0]
ds_write_b32 v2, v26 offset:7616
v_pk_mul_f32 v[24:25], v[22:23], v[18:19] op_sel:[0,0] op_sel_hi:[0,1]
v_cvt_pk_bf16_f32 v28, v22, v23
v_pk_fma_f32 v[24:25], v[22:23], v[18:19], v[24:25] op_sel:[1,1,0] op_sel_hi:[1,0,1] neg_lo:[0,1,0]
ds_write_b32 v2, v27 offset:7888
v_cvt_pk_bf16_f32 v29, v24, v25
ds_write_b32 v2, v28 offset:8160
ds_write_b32 v2, v29 offset:8432
v_mul_f32 v11, 0x3f800000, v9
v_mul_f32 v10, 0x3f800000, v8
v_fract_f32 v11, v11
v_exp_f32 v10, v10
v_cos_f32 v16, v11
v_sin_f32 v17, v11
v_mul_f32 v11, 0x43800000, v9
v_mul_f32 v16, v16, v10
v_mul_f32 v17, v17, v10
v_mul_f32 v10, 0x43800000, v8
v_fract_f32 v11, v11
v_exp_f32 v10, v10
v_cos_f32 v20, v11
v_sin_f32 v21, v11
v_mul_f32 v20, v20, v10
v_mul_f32 v21, v21, v10
ds_read_b128 v[32:35], v7 offset:0
ds_read_b128 v[36:39], v7 offset:32
ds_read_b128 v[40:43], v7 offset:64
ds_read_b128 v[44:47], v7 offset:96
ds_read_b128 v[48:51], v7 offset:128
ds_read_b128 v[52:55], v7 offset:160
ds_read_b128 v[56:59], v7 offset:192
ds_read_b128 v[60:63], v7 offset:224
v_pk_mul_f32 v[24:25], v[14:15], v[16:17] op_sel:[0,0] op_sel_hi:[0,1]
v_cvt_pk_bf16_f32 v26, v14, -v15
v_pk_fma_f32 v[24:25], v[14:15], v[16:17], v[24:25] op_sel:[1,1,0] op_sel_hi:[1,0,1] neg_lo:[0,1,0]
v_pk_mul_f32 v[64:65], v[16:17], v[16:17] op_sel:[0,0] op_sel_hi:[0,1]
v_pk_mul_f32 v[22:23], v[24:25], v[16:17] op_sel:[0,0] op_sel_hi:[0,1]
v_cvt_pk_bf16_f32 v27, v24, -v25
v_pk_fma_f32 v[22:23], v[24:25], v[16:17], v[22:23] op_sel:[1,1,0] op_sel_hi:[1,0,1] neg_lo:[0,1,0]
ds_write_b32 v2, v26 offset:0
v_pk_mul_f32 v[24:25], v[22:23], v[16:17] op_sel:[0,0] op_sel_hi:[0,1]
v_cvt_pk_bf16_f32 v28, v22, -v23
v_pk_fma_f32 v[24:25], v[22:23], v[16:17], v[24:25] op_sel:[1,1,0] op_sel_hi:[1,0,1] neg_lo:[0,1,0]
v_pk_fma_f32 v[64:65], v[16:17], v[16:17], v[64:65] op_sel:[1,1,0] op_sel_hi:[1,0,1] neg_lo:[0,1,0]
v_pk_mul_f32 v[22:23], v[24:25], v[16:17] op_sel:[0,0] op_sel_hi:[0,1]
v_cvt_pk_bf16_f32 v29, v24, -v25
v_pk_fma_f32 v[22:23], v[24:25], v[16:17], v[22:23] op_sel:[1,1,0] op_sel_hi:[1,0,1] neg_lo:[0,1,0]
v_pk_mul_f32 v[70:71], v[14:15], v[20:21] op_sel:[0,0] op_sel_hi:[0,1]
v_pk_mul_f32 v[24:25], v[22:23], v[16:17] op_sel:[0,0] op_sel_hi:[0,1]
v_cvt_pk_bf16_f32 v26, v22, -v23
v_pk_fma_f32 v[24:25], v[22:23], v[16:17], v[24:25] op_sel:[1,1,0] op_sel_hi:[1,0,1] neg_lo:[0,1,0]
v_pk_mul_f32 v[66:67], v[64:65], v[64:65] op_sel:[0,0] op_sel_hi:[0,1]
v_pk_mul_f32 v[22:23], v[24:25], v[16:17] op_sel:[0,0] op_sel_hi:[0,1]
ds_write_b32 v2, v27 offset:272
v_pk_fma_f32 v[22:23], v[24:25], v[16:17], v[22:23] op_sel:[1,1,0] op_sel_hi:[1,0,1] neg_lo:[0,1,0]
v_cvt_pk_bf16_f32 v27, v24, -v25
v_pk_fma_f32 v[70:71], v[14:15], v[20:21], v[70:71] op_sel:[1,1,0] op_sel_hi:[1,0,1] neg_lo:[0,1,0]
v_pk_fma_f32 v[66:67], v[64:65], v[64:65], v[66:67] op_sel:[1,1,0] op_sel_hi:[1,0,1] neg_lo:[0,1,0]
v_pk_mul_f32 v[24:25], v[22:23], v[16:17] op_sel:[0,0] op_sel_hi:[0,1]
ds_write_b32 v2, v28 offset:544
v_pk_mul_f32 v[74:75], v[70:71], v[64:65] op_sel:[0,0] op_sel_hi:[0,1]
v_pk_mul_f32 v[68:69], v[66:67], v[64:65] op_sel:[0,0] op_sel_hi:[0,1]
v_cvt_pk_bf16_f32 v28, v22, -v23
v_pk_fma_f32 v[24:25], v[22:23], v[16:17], v[24:25] op_sel:[1,1,0] op_sel_hi:[1,0,1] neg_lo:[0,1,0]
v_pk_mul_f32 v[22:23], v[70:71], v[66:67] op_sel:[0,0] op_sel_hi:[0,1]
v_pk_fma_f32 v[74:75], v[70:71], v[64:65], v[74:75] op_sel:[1,1,0] op_sel_hi:[1,0,1] neg_lo:[0,1,0]
v_pk_fma_f32 v[68:69], v[66:67], v[64:65], v[68:69] op_sel:[1,1,0] op_sel_hi:[1,0,1] neg_lo:[0,1,0]
ds_write_b32 v2, v29 offset:816
v_pk_fma_f32 v[22:23], v[70:71], v[66:67], v[22:23] op_sel:[1,1,0] op_sel_hi:[1,0,1] neg_lo:[0,1,0]
ds_write_b32 v2, v26 offset:1088
ds_write_b32 v2, v27 offset:1360
v_pk_mul_f32 v[72:73], v[70:71], v[20:21] op_sel:[0,0] op_sel_hi:[0,1]
v_cvt_pk_bf16_f32 v27, v74, -v75
ds_write_b32 v2, v28 offset:1632
v_pk_mul_f32 v[74:75], v[70:71], v[68:69] op_sel:[0,0] op_sel_hi:[0,1]
v_cvt_pk_bf16_f32 v28, v22, -v23
v_pk_mul_f32 v[22:23], v[70:71], v[18:19] op_sel:[0,0] op_sel_hi:[0,1]
v_pk_fma_f32 v[72:73], v[70:71], v[20:21], v[72:73] op_sel:[1,1,0] op_sel_hi:[1,0,1] neg_lo:[0,1,0]
v_cvt_pk_bf16_f32 v29, v24, -v25
v_pk_fma_f32 v[74:75], v[70:71], v[68:69], v[74:75] op_sel:[1,1,0] op_sel_hi:[1,0,1] neg_lo:[0,1,0]
v_cvt_pk_bf16_f32 v26, v70, -v71
v_pk_fma_f32 v[22:23], v[70:71], v[18:19], v[22:23] op_sel:[1,1,0] op_sel_hi:[1,0,1] neg_lo:[0,1,0]
v_pk_mul_f32 v[70:71], v[72:73], v[20:21] op_sel:[0,0] op_sel_hi:[0,1]
ds_write_b32 v2, v29 offset:1904
v_cvt_pk_bf16_f32 v29, v74, -v75
v_pk_mul_f32 v[74:75], v[72:73], v[66:67] op_sel:[0,0] op_sel_hi:[0,1]
v_pk_fma_f32 v[70:71], v[72:73], v[20:21], v[70:71] op_sel:[1,1,0] op_sel_hi:[1,0,1] neg_lo:[0,1,0]
ds_write_b32 v2, v26 offset:2176
ds_write_b32 v2, v26 offset:2448
ds_write_b32 v2, v27 offset:2720
v_pk_fma_f32 v[74:75], v[72:73], v[66:67], v[74:75] op_sel:[1,1,0] op_sel_hi:[1,0,1] neg_lo:[0,1,0]
v_cvt_pk_bf16_f32 v27, v72, -v73
v_pk_mul_f32 v[72:73], v[70:71], v[20:21] op_sel:[0,0] op_sel_hi:[0,1]
ds_write_b32 v2, v28 offset:2992
v_pk_fma_f32 v[72:73], v[70:71], v[20:21], v[72:73] op_sel:[1,1,0] op_sel_hi:[1,0,1] neg_lo:[0,1,0]
v_cvt_pk_bf16_f32 v26, v22, -v23
ds_write_b32 v2, v28 offset:3264
ds_write_b32 v2, v28 offset:3536
v_cvt_pk_bf16_f32 v28, v74, -v75
v_pk_mul_f32 v[74:75], v[70:71], v[66:67] op_sel:[0,0] op_sel_hi:[0,1]
v_pk_fma_f32 v[74:75], v[70:71], v[66:67], v[74:75] op_sel:[1,1,0] op_sel_hi:[1,0,1] neg_lo:[0,1,0]
ds_write_b32 v2, v29 offset:3808
v_cvt_pk_bf16_f32 v29, v70, -v71
v_pk_mul_f32 v[70:71], v[72:73], v[20:21] op_sel:[0,0] op_sel_hi:[0,1]
v_pk_fma_f32 v[70:71], v[72:73], v[20:21], v[70:71] op_sel:[1,1,0] op_sel_hi:[1,0,1] neg_lo:[0,1,0]
ds_write_b32 v2, v26 offset:4080
v_cvt_pk_bf16_f32 v26, v74, -v75
ds_write_b32 v2, v27 offset:4352
v_cvt_pk_bf16_f32 v27, v72, -v73
v_pk_mul_f32 v[72:73], v[70:71], v[20:21] op_sel:[0,0] op_sel_hi:[0,1]
v_pk_fma_f32 v[72:73], v[70:71], v[20:21], v[72:73] op_sel:[1,1,0] op_sel_hi:[1,0,1] neg_lo:[0,1,0]
ds_write_b32 v2, v28 offset:4624
v_cvt_pk_bf16_f32 v28, v70, -v71
v_pk_mul_f32 v[70:71], v[72:73], v[20:21] op_sel:[0,0] op_sel_hi:[0,1]
v_pk_fma_f32 v[70:71], v[72:73], v[20:21], v[70:71] op_sel:[1,1,0] op_sel_hi:[1,0,1] neg_lo:[0,1,0]
ds_write_b32 v2, v29 offset:4896
v_cvt_pk_bf16_f32 v29, v72, -v73
v_pk_mul_f32 v[72:73], v[70:71], v[20:21] op_sel:[0,0] op_sel_hi:[0,1]
v_pk_fma_f32 v[72:73], v[70:71], v[20:21], v[72:73] op_sel:[1,1,0] op_sel_hi:[1,0,1] neg_lo:[0,1,0]
ds_write_b32 v2, v26 offset:5168
v_cvt_pk_bf16_f32 v26, v70, -v71
ds_write_b32 v2, v27 offset:5440
v_cvt_pk_bf16_f32 v27, v72, -v73
ds_write_b32 v2, v28 offset:5712
ds_write_b32 v2, v29 offset:5984
ds_write_b32 v2, v26 offset:6256
ds_write_b32 v2, v27 offset:6528
ds_read_b128 v[64:67], v7 offset:0
ds_read_b128 v[68:71], v7 offset:32
ds_read_b128 v[72:75], v7 offset:64
ds_read_b128 v[76:79], v7 offset:96
s_waitcnt lgkmcnt(3)
v_mfma_f32_32x32x16_bf16 v[80:95], v[64:67], v[32:35], 0
ds_read_b128 v[64:67], v7 offset:128
s_waitcnt lgkmcnt(3)
v_mfma_f32_32x32x16_bf16 v[80:95], v[68:71], v[36:39], v[80:95]
ds_read_b128 v[68:71], v7 offset:160
s_waitcnt lgkmcnt(3)
v_mfma_f32_32x32x16_bf16 v[80:95], v[72:75], v[40:43], v[80:95]
ds_read_b128 v[72:75], v7 offset:192
s_waitcnt lgkmcnt(3)
v_mfma_f32_32x32x16_bf16 v[80:95], v[76:79], v[44:47], v[80:95]
ds_read_b128 v[76:79], v7 offset:224
s_waitcnt lgkmcnt(3)
v_mfma_f32_32x32x16_bf16 v[80:95], v[64:67], v[48:51], v[80:95]
s_waitcnt lgkmcnt(2)
v_mfma_f32_32x32x16_bf16 v[80:95], v[68:71], v[52:55], v[80:95]
s_waitcnt lgkmcnt(1)
v_mfma_f32_32x32x16_bf16 v[80:95], v[72:75], v[56:59], v[80:95]
s_waitcnt lgkmcnt(0)
v_mfma_f32_32x32x16_bf16 v[80:95], v[76:79], v[60:63], v[80:95]
v_lshlrev_b32 v5, 4, v1
s_cmp_eq_u32 s73, 0
s_waitcnt vmcnt(0)
s_nop 8
s_cbranch_scc1 KG_H0
v_add_u32 v6, s76, v5
ds_write_b128 v6, v[80:83] offset:0
ds_write_b128 v6, v[84:87] offset:1024
ds_write_b128 v6, v[88:91] offset:2048
ds_write_b128 v6, v[92:95] offset:3072
s_waitcnt lgkmcnt(0)
s_barrier
s_endpgm
KG_H0:
s_barrier
s_add_u32 s77, s76, 8704
v_cmp_eq_u32 vcc, 0, v1
v_add_u32 v6, s77, v5
v_lshlrev_b32 v30, 16, v30
ds_read_b128 v[32:35], v6 offset:0
ds_read_b128 v[36:39], v6 offset:1024
ds_read_b128 v[40:43], v6 offset:2048
v_lshlrev_b32 v8, 4, v3
v_lshlrev_b32 v9, 3, v4
v_cndmask_b32 v30, 0, v30, vcc
v_add_u32 v8, v8, v9
ds_read_b128 v[44:47], v6 offset:3072
v_sub_u32 v8, 1112, v8
v_add_u32 v6, s76, v5
v_mov_b32 v16, 0
v_mov_b32 v17, 0
v_mov_b32 v18, 0
v_mov_b32 v19, 0
v_and_b32 v11, 1, v3
v_cmp_eq_u32 s[78:79], 1, v4
v_add_u32 v8, s76, v8
ds_write_b128 v6, v[16:19] offset:0
v_add_u32 v10, 1, v3
v_mul_u32_u24 v11, 160, v11
ds_write_b128 v6, v[16:19] offset:1024
ds_write_b128 v6, v[16:19] offset:2048
v_cmp_eq_u32 s[80:81], 0, v3
v_subrev_u32 v9, 512, v8
v_and_b32 v10, -2, v10
v_add_u32 v11, 1824, v11
v_cmp_eq_u32 vcc, 0, v1
v_sub_u32 v11, v11, v10
s_waitcnt lgkmcnt(6)
v_pk_add_f32 v[80:81], v[80:81], v[32:33]
v_pk_add_f32 v[82:83], v[82:83], v[34:35]
v_add_f32 v80, v80, v30
v_cvt_pk_bf16_f32 v20, v83, v82
v_cvt_pk_bf16_f32 v21, v81, v80
s_waitcnt lgkmcnt(5)
v_pk_add_f32 v[84:85], v[84:85], v[36:37]
v_pk_add_f32 v[86:87], v[86:87], v[38:39]
ds_write_b64 v8, v[20:21]
v_cvt_pk_bf16_f32 v20, v87, v86
v_cvt_pk_bf16_f32 v21, v85, v84
v_mov_b32 v13, v11
ds_write_b64 v9, v[20:21]
v_lshlrev_b32 v9, 1, v3
s_waitcnt lgkmcnt(6)
v_pk_add_f32 v[88:89], v[88:89], v[40:41]
v_sub_u32 v12, 1376, v9
v_cvt_pk_bf16_f32 v20, v88, v89
v_cndmask_b32 v12, v12, v13, s[78:79]
v_mov_b32 v13, 2800
v_pk_add_f32 v[90:91], v[90:91], v[42:43]
v_cndmask_b32 v12, v12, v13, s[80:81]
v_subrev_u32 v13, 32, v11
v_add_u32 v12, s76, v12
v_cvt_pk_bf16_f32 v21, v90, v91
ds_write_b16 v12, v20
v_sub_u32 v12, 1630, v9
s_waitcnt lgkmcnt(6)
v_pk_add_f32 v[92:93], v[92:93], v[44:45]
v_cndmask_b32 v12, v12, v13, s[78:79]
v_subrev_u32 v13, 64, v11
v_add_u32 v12, s76, v12
v_cvt_pk_bf16_f32 v22, v92, v92
ds_write_b16_d16_hi v12, v20
v_sub_u32 v12, 1312, v9
s_mul_i32 s75, s72, 2304
v_cndmask_b32 v12, v12, v13, s[78:79]
v_subrev_u32 v13, 96, v11
v_add_u32 v12, s76, v12
v_pk_add_f32 v[94:95], v[94:95], v[46:47]
ds_write_b16 v12, v21
v_sub_u32 v12, 1566, v9
v_cndmask_b32 v12, v12, v13, s[78:79]
v_mov_b32 v13, 1248
v_add_u32 v12, s76, v12
ds_write_b16_d16_hi v12, v21
v_mov_b32 v12, 94
v_cndmask_b32 v12, v12, v13, s[78:79]
v_mov_b32 v13, 2800
v_cndmask_b32 v12, v13, v12, s[80:81]
v_mov_b32 v13, 2136
v_add_u32 v12, s76, v12
ds_write_b16 v12, v20
v_mov_b32 v12, 92
v_cndmask_b32 v12, v12, v13, s[78:79]
v_mov_b32 v13, 2800
v_cndmask_b32 v12, v13, v12, s[80:81]
v_mov_b32 v13, 2134
v_add_u32 v12, s76, v12
ds_write_b16 v12, v20
v_mov_b32 v12, 90
v_cndmask_b32 v12, v12, v13, s[78:79]
v_mov_b32 v13, 2800
v_cndmask_b32 v12, v13, v12, s[80:81]
v_mov_b32 v13, 2800
v_add_u32 v12, s76, v12
ds_write_b16 v12, v20
v_mov_b32 v12, 1696
v_cndmask_b32 v12, v13, v12, vcc
v_cmp_gt_u32 vcc, 16, v1
v_add_u32 v12, s76, v12
ds_write_b16 v12, v22
v_mov_b32 v12, 0x80000000
v_cndmask_b32 v12, v12, v5, vcc
ds_read_b128 v[32:35], v6 offset:0
ds_read_b128 v[36:39], v6 offset:1024
ds_read_b128 v[40:43], v6 offset:2048
s_waitcnt lgkmcnt(2)
buffer_store_dwordx4 v[32:35], v5, s[68:71], s75 offen sc1
s_waitcnt lgkmcnt(1)
buffer_store_dwordx4 v[36:39], v5, s[68:71], s75 offen offset:1024 sc1
s_waitcnt lgkmcnt(0)
buffer_store_dwordx4 v[40:43], v12, s[68:71], s75 offen offset:2048 sc1
s_endpgm
s_nop 0
k1_kernel_P1:
s_sub_u32 s3, s2, 320
s_mov_b32 s44, s30
s_mov_b32 s45, s31
s_and_b32 s45, s45, 0xffff
s_mov_b32 s46, 0x280000
s_mov_b32 s47, 0x20000
s_mov_b32 s48, s40
s_mov_b32 s49, s41
s_and_b32 s49, s49, 0xffff
s_mov_b32 s50, 0x2a0000
s_mov_b32 s51, 0x20000
v_and_b32 v1, 63, v0
v_and_b32 v2, 15, v1
v_lshrrev_b32 v3, 4, v1
v_lshrrev_b32 v4, 6, v0
s_nop 0
v_readfirstlane_b32 s60, v4
s_mul_i32 s61, s3, 1280
s_add_u32 s62, s61, 327680
s_add_u32 s63, s61, 655360
s_add_u32 s64, s61, 983040
s_add_u32 s65, s61, 1310720
s_add_u32 s66, s61, 1638400
s_add_u32 s67, s61, 1966080
s_add_u32 s68, s61, 2293760
v_lshlrev_b32 v5, 3, v0
v_mov_b32 v6, 0x80000000
v_cmp_gt_u32 vcc, 160, v0
s_nop 1
v_cndmask_b32 v6, v6, v5, vcc
buffer_load_dwordx2 v[8:9], v6, s[44:47], s61 offen
buffer_load_dwordx2 v[10:11], v6, s[44:47], s62 offen
buffer_load_dwordx2 v[12:13], v6, s[44:47], s63 offen
buffer_load_dwordx2 v[14:15], v6, s[44:47], s64 offen
buffer_load_dwordx2 v[16:17], v6, s[44:47], s65 offen
buffer_load_dwordx2 v[18:19], v6, s[44:47], s66 offen
buffer_load_dwordx2 v[20:21], v6, s[44:47], s67 offen
buffer_load_dwordx2 v[22:23], v6, s[44:47], s68 offen
v_cvt_f32_u32 v48, v2
v_lshlrev_b32 v49, 2, v3
v_cvt_f32_u32 v49, v49
v_mov_b32 v50, v48
v_mul_f32 v50, 0x3acccccd, v50
v_mul_f32 v51, v49, v50
v_cos_f32 v24, v51
v_sin_f32 v32, v51
v_fmamk_f32 v52, v50, 0x3f800000, v51
v_cos_f32 v25, v52
v_sin_f32 v33, v52
v_fmamk_f32 v52, v50, 0x40000000, v51
v_cos_f32 v26, v52
v_sin_f32 v34, v52
v_fmamk_f32 v52, v50, 0x40400000, v51
v_cos_f32 v27, v52
v_sin_f32 v35, v52
v_add_f32 v50, 0x41800000, v48
v_mul_f32 v50, 0x3acccccd, v50
v_mul_f32 v51, v49, v50
v_cos_f32 v28, v51
v_sin_f32 v36, v51
v_fmamk_f32 v52, v50, 0x3f800000, v51
v_cos_f32 v29, v52
v_sin_f32 v37, v52
v_fmamk_f32 v52, v50, 0x40000000, v51
v_cos_f32 v30, v52
v_sin_f32 v38, v52
v_fmamk_f32 v52, v50, 0x40400000, v51
v_cos_f32 v31, v52
v_sin_f32 v39, v52
v_lshrrev_b32 v55, 3, v2
v_mul_u32_u24 v55, 0x8000, v55
v_lshl_or_b32 v55, v55, 16, v55
v_mul_f32 v50, 0x3d800000, v48
v_mul_f32 v51, v49, v50
v_cos_f32 v53, v51
v_sin_f32 v54, v51
s_nop 0
v_cvt_pk_bf16_f32 v40, v53, v54
v_cvt_pk_bf16_f32 v44, -v54, v53
v_xor_b32 v44, v44, v55
v_fmamk_f32 v52, v50, 0x3f800000, v51
v_cos_f32 v53, v52
v_sin_f32 v54, v52
s_nop 0
v_cvt_pk_bf16_f32 v41, v53, v54
v_cvt_pk_bf16_f32 v45, -v54, v53
v_xor_b32 v45, v45, v55
v_fmamk_f32 v52, v50, 0x40000000, v51
v_cos_f32 v53, v52
v_sin_f32 v54, v52
s_nop 0
v_cvt_pk_bf16_f32 v42, v53, v54
v_cvt_pk_bf16_f32 v46, -v54, v53
v_xor_b32 v46, v46, v55
v_fmamk_f32 v52, v50, 0x40400000, v51
v_cos_f32 v53, v52
v_sin_f32 v54, v52
s_nop 0
v_cvt_pk_bf16_f32 v43, v53, v54
v_cvt_pk_bf16_f32 v47, -v54, v53
v_xor_b32 v47, v47, v55
s_lshr_b32 s70, s60, 1
s_and_b32 s71, s60, 1
s_lshl_b32 s72, s71, 4
s_lshl_b32 s73, s70, 5
v_add_u32 v50, s72, v2
v_cvt_f32_u32 v51, v50
v_mul_f32 v51, 0x3ccccccd, v51
v_lshlrev_b32 v52, 2, v3
v_add_u32 v52, s73, v52
v_cmp_gt_u32 vcc, 21, v50
v_cmp_gt_u32 s[74:75], 40, v52
s_nop 3
s_and_b64 vcc, vcc, s[74:75]
v_cvt_f32_u32 v52, v52
v_mul_f32 v52, v52, v51
v_cos_f32 v56, v52
v_sin_f32 v64, v52
v_fmamk_f32 v53, v51, 0x3f800000, v52
v_cos_f32 v57, v53
v_sin_f32 v65, v53
v_fmamk_f32 v53, v51, 0x40000000, v52
v_cos_f32 v58, v53
v_sin_f32 v66, v53
v_fmamk_f32 v53, v51, 0x40400000, v52
v_cos_f32 v59, v53
v_sin_f32 v67, v53
v_fmamk_f32 v53, v51, 0x41800000, v52
v_cos_f32 v60, v53
v_sin_f32 v68, v53
v_fmamk_f32 v53, v51, 0x41880000, v52
v_cos_f32 v61, v53
v_sin_f32 v69, v53
v_fmamk_f32 v53, v51, 0x41900000, v52
v_cos_f32 v62, v53
v_sin_f32 v70, v53
v_fmamk_f32 v53, v51, 0x41980000, v52
v_cos_f32 v63, v53
v_sin_f32 v71, v53
v_cvt_pk_bf16_f32 v72, v56, v57
v_cvt_pk_bf16_f32 v76, -v64, -v65
v_cvt_pk_bf16_f32 v73, v58, v59
v_cvt_pk_bf16_f32 v77, -v66, -v67
v_cvt_pk_bf16_f32 v74, v60, v61
v_cvt_pk_bf16_f32 v78, -v68, -v69
v_cvt_pk_bf16_f32 v75, v62, v63
v_cvt_pk_bf16_f32 v79, -v70, -v71
v_cndmask_b32 v72, 0, v72, vcc
v_cndmask_b32 v73, 0, v73, vcc
v_cndmask_b32 v74, 0, v74, vcc
v_cndmask_b32 v75, 0, v75, vcc
v_cndmask_b32 v76, 0, v76, vcc
v_cndmask_b32 v77, 0, v77, vcc
v_cndmask_b32 v78, 0, v78, vcc
v_cndmask_b32 v79, 0, v79, vcc
s_lshl_b32 s72, s70, 2
s_lshl_b32 s73, s71, 1
s_add_u32 s72, s72, s73
s_lshl_b32 s72, s72, 10
s_add_u32 s72, s72, 16384
v_lshlrev_b32 v50, 4, v1
v_add_u32 v51, s72, v50
ds_write_b128 v51, v[72:75]
ds_write_b128 v51, v[76:79] offset:1024
s_waitcnt vmcnt(7)
v_lshlrev_b32 v80, 16, v8
v_and_b32 v81, 0xffff0000, v8
s_waitcnt vmcnt(6)
v_lshlrev_b32 v82, 16, v10
v_and_b32 v83, 0xffff0000, v10
s_waitcnt vmcnt(5)
v_lshlrev_b32 v84, 16, v12
v_and_b32 v85, 0xffff0000, v12
s_waitcnt vmcnt(4)
v_lshlrev_b32 v86, 16, v14
v_and_b32 v87, 0xffff0000, v14
s_waitcnt vmcnt(3)
v_lshlrev_b32 v88, 16, v16
v_and_b32 v89, 0xffff0000, v16
s_waitcnt vmcnt(2)
v_lshlrev_b32 v90, 16, v18
v_and_b32 v91, 0xffff0000, v18
s_waitcnt vmcnt(1)
v_lshlrev_b32 v92, 16, v20
v_and_b32 v93, 0xffff0000, v20
s_waitcnt vmcnt(0)
v_lshlrev_b32 v94, 16, v22
v_and_b32 v95, 0xffff0000, v22
v_pk_add_f32 v[96:97], v[80:81], v[88:89]
v_pk_add_f32 v[100:101], v[84:85], v[92:93]
v_pk_add_f32 v[104:105], v[82:83], v[90:91]
v_pk_add_f32 v[106:107], v[82:83], v[90:91] neg_lo:[0,1] neg_hi:[0,1]
v_pk_add_f32 v[108:109], v[86:87], v[94:95]
v_pk_add_f32 v[110:111], v[86:87], v[94:95] neg_lo:[0,1] neg_hi:[0,1]
s_mov_b32 s76, 0x3f3504f3
v_pk_add_f32 v[98:99], v[80:81], v[88:89] neg_lo:[0,1] neg_hi:[0,1]
v_pk_add_f32 v[102:103], v[84:85], v[92:93] neg_lo:[0,1] neg_hi:[0,1]
s_mov_b32 s77, 0x3f3504f3
v_pk_add_f32 v[80:81], v[96:97], v[100:101]
v_pk_add_f32 v[82:83], v[104:105], v[108:109]
v_pk_add_f32 v[84:85], v[106:107], v[110:111] neg_lo:[0,1] neg_hi:[0,1]
v_pk_add_f32 v[86:87], v[106:107], v[110:111]
v_pk_add_f32 v[88:89], v[80:81], v[82:83]
v_pk_add_f32 v[90:91], v[80:81], v[82:83] neg_lo:[0,1] neg_hi:[0,1]
v_pk_fma_f32 v[92:93], v[84:85], s[76:77], v[98:99]
v_pk_fma_f32 v[94:95], v[86:87], s[76:77], v[102:103] neg_lo:[1,0,1] neg_hi:[1,0,1]
v_pk_fma_f32 v[116:117], v[84:85], s[76:77], v[98:99] neg_lo:[1,0,0] neg_hi:[1,0,0]
v_pk_fma_f32 v[118:119], v[86:87], s[76:77], v[102:103] neg_lo:[1,0,0] neg_hi:[1,0,0]
v_cvt_pk_bf16_f32 v56, v88, v89
v_cvt_pk_bf16_f32 v58, v90, v91
v_cvt_pk_bf16_f32 v60, v92, v93
v_cvt_pk_bf16_f32 v62, v94, v95
v_lshlrev_b32 v80, 16, v9
v_and_b32 v81, 0xffff0000, v9
v_lshlrev_b32 v82, 16, v11
v_and_b32 v83, 0xffff0000, v11
v_lshlrev_b32 v84, 16, v13
v_and_b32 v85, 0xffff0000, v13
v_lshlrev_b32 v86, 16, v15
v_and_b32 v87, 0xffff0000, v15
v_lshlrev_b32 v88, 16, v17
v_and_b32 v89, 0xffff0000, v17
v_lshlrev_b32 v90, 16, v19
v_and_b32 v91, 0xffff0000, v19
v_lshlrev_b32 v92, 16, v21
v_and_b32 v93, 0xffff0000, v21
v_lshlrev_b32 v94, 16, v23
v_and_b32 v95, 0xffff0000, v23
v_pk_add_f32 v[112:113], v[96:97], v[100:101] neg_lo:[0,1] neg_hi:[0,1]
v_pk_add_f32 v[114:115], v[108:109], v[104:105] neg_lo:[0,1] neg_hi:[0,1]
v_pk_add_f32 v[96:97], v[80:81], v[88:89]
v_pk_add_f32 v[100:101], v[84:85], v[92:93]
v_pk_add_f32 v[104:105], v[82:83], v[90:91]
v_pk_add_f32 v[108:109], v[86:87], v[94:95]
v_pk_add_f32 v[106:107], v[82:83], v[90:91] neg_lo:[0,1] neg_hi:[0,1]
v_pk_add_f32 v[110:111], v[86:87], v[94:95] neg_lo:[0,1] neg_hi:[0,1]
v_pk_add_f32 v[98:99], v[80:81], v[88:89] neg_lo:[0,1] neg_hi:[0,1]
v_pk_add_f32 v[80:81], v[96:97], v[100:101]
v_pk_add_f32 v[82:83], v[104:105], v[108:109]
v_pk_add_f32 v[102:103], v[84:85], v[92:93] neg_lo:[0,1] neg_hi:[0,1]
v_pk_add_f32 v[84:85], v[106:107], v[110:111] neg_lo:[0,1] neg_hi:[0,1]
v_pk_add_f32 v[86:87], v[106:107], v[110:111]
v_pk_add_f32 v[88:89], v[80:81], v[82:83]
v_pk_add_f32 v[90:91], v[80:81], v[82:83] neg_lo:[0,1] neg_hi:[0,1]
v_pk_fma_f32 v[92:93], v[84:85], s[76:77], v[98:99]
v_cvt_pk_bf16_f32 v64, v112, v113
v_pk_fma_f32 v[94:95], v[86:87], s[76:77], v[102:103] neg_lo:[1,0,1] neg_hi:[1,0,1]
v_cvt_pk_bf16_f32 v66, v114, v115
v_pk_add_f32 v[112:113], v[96:97], v[100:101] neg_lo:[0,1] neg_hi:[0,1]
v_cvt_pk_bf16_f32 v68, v116, v117
v_pk_add_f32 v[114:115], v[108:109], v[104:105] neg_lo:[0,1] neg_hi:[0,1]
v_cvt_pk_bf16_f32 v57, v88, v89
v_cvt_pk_bf16_f32 v70, v118, v119
v_pk_fma_f32 v[116:117], v[84:85], s[76:77], v[98:99] neg_lo:[1,0,0] neg_hi:[1,0,0]
v_cvt_pk_bf16_f32 v59, v90, v91
v_pk_fma_f32 v[118:119], v[86:87], s[76:77], v[102:103] neg_lo:[1,0,0] neg_hi:[1,0,0]
v_cvt_pk_bf16_f32 v61, v92, v93
v_cvt_pk_bf16_f32 v63, v94, v95
v_cvt_pk_bf16_f32 v65, v112, v113
v_cvt_pk_bf16_f32 v67, v114, v115
ds_write_b64 v5, v[56:57] offset:0
v_cvt_pk_bf16_f32 v69, v116, v117
ds_write_b64 v5, v[58:59] offset:2048
v_cvt_pk_bf16_f32 v71, v118, v119
ds_write_b64 v5, v[60:61] offset:4096
ds_write_b64 v5, v[62:63] offset:6144
ds_write_b64 v5, v[64:65] offset:8192
ds_write_b64 v5, v[66:67] offset:10240
ds_write_b64 v5, v[68:69] offset:12288
ds_write_b64 v5, v[70:71] offset:14336
s_waitcnt lgkmcnt(0)
s_barrier
v_lshlrev_b32 v50, 4, v1
s_lshl_b32 s72, s60, 12
v_lshlrev_b32 v51, 3, v1
v_add_u32 v50, 16384, v50
v_add_u32 v51, s72, v51
ds_read_b128 v[56:59], v50 offset:0
ds_read_b128 v[60:63], v50 offset:1024
ds_read_b64_tr_b16 v[8:9], v51 offset:0
ds_read_b64_tr_b16 v[10:11], v51 offset:512
ds_read_b64 v[72:73], v50 offset:4096
ds_read_b64 v[74:75], v50 offset:5120
ds_read_b64_tr_b16 v[12:13], v51 offset:1024
ds_read_b128 v[64:67], v50 offset:2048
ds_read_b128 v[68:71], v50 offset:3072
ds_read_b64 v[76:77], v50 offset:6144
s_waitcnt lgkmcnt(6)
v_mfma_f32_16x16x32_bf16 v[80:83], v[8:11], v[56:59], 0
ds_read_b64 v[78:79], v50 offset:7168
v_mfma_f32_16x16x32_bf16 v[84:87], v[8:11], v[60:63], 0
ds_read_b64_tr_b16 v[14:15], v51 offset:2048
ds_read_b64_tr_b16 v[16:17], v51 offset:2560
s_waitcnt lgkmcnt(6)
v_mfma_f32_16x16x16_bf16 v[80:83], v[12:13], v[72:73], v[80:83]
ds_read_b64_tr_b16 v[18:19], v51 offset:3072
v_mfma_f32_16x16x16_bf16 v[84:87], v[12:13], v[74:75], v[84:87]
s_waitcnt lgkmcnt(6)
v_mfma_f32_16x16x32_bf16 v[88:91], v[8:11], v[64:67], 0
v_pk_mul_f32 v[112:113], v[80:81], v[24:25]
s_waitcnt lgkmcnt(5)
v_mfma_f32_16x16x32_bf16 v[92:95], v[8:11], v[68:71], 0
v_pk_mul_f32 v[114:115], v[84:85], v[24:25]
v_pk_fma_f32 v[112:113], v[84:85], v[32:33], v[112:113]
s_waitcnt lgkmcnt(4)
v_mfma_f32_16x16x16_bf16 v[88:91], v[12:13], v[76:77], v[88:91]
v_pk_fma_f32 v[114:115], v[80:81], v[32:33], v[114:115] neg_lo:[1,0,0] neg_hi:[1,0,0]
v_cvt_pk_bf16_f32 v8, v112, v114
s_waitcnt lgkmcnt(3)
v_mfma_f32_16x16x16_bf16 v[92:95], v[12:13], v[78:79], v[92:95]
v_cvt_pk_bf16_f32 v9, v113, v115
v_pk_mul_f32 v[112:113], v[82:83], v[26:27]
s_waitcnt lgkmcnt(1)
v_mfma_f32_16x16x32_bf16 v[96:99], v[14:17], v[56:59], 0
v_pk_mul_f32 v[114:115], v[86:87], v[26:27]
v_pk_fma_f32 v[112:113], v[86:87], v[34:35], v[112:113]
v_mfma_f32_16x16x32_bf16 v[100:103], v[14:17], v[60:63], 0
v_pk_fma_f32 v[114:115], v[82:83], v[34:35], v[114:115] neg_lo:[1,0,0] neg_hi:[1,0,0]
v_cvt_pk_bf16_f32 v10, v112, v114
s_waitcnt lgkmcnt(0)
v_mfma_f32_16x16x16_bf16 v[96:99], v[18:19], v[72:73], v[96:99]
v_cvt_pk_bf16_f32 v11, v113, v115
v_pk_mul_f32 v[112:113], v[88:89], v[28:29]
v_mfma_f32_16x16x16_bf16 v[100:103], v[18:19], v[74:75], v[100:103]
v_pk_mul_f32 v[114:115], v[92:93], v[28:29]
v_pk_fma_f32 v[112:113], v[92:93], v[36:37], v[112:113]
v_mfma_f32_16x16x32_bf16 v[104:107], v[14:17], v[64:67], 0
v_pk_fma_f32 v[114:115], v[88:89], v[36:37], v[114:115] neg_lo:[1,0,0] neg_hi:[1,0,0]
v_cvt_pk_bf16_f32 v12, v112, v114
v_mfma_f32_16x16x32_bf16 v[108:111], v[14:17], v[68:71], 0
v_cvt_pk_bf16_f32 v13, v113, v115
v_pk_mul_f32 v[112:113], v[90:91], v[30:31]
v_mfma_f32_16x16x16_bf16 v[104:107], v[18:19], v[76:77], v[104:107]
v_pk_mul_f32 v[114:115], v[94:95], v[30:31]
v_pk_fma_f32 v[112:113], v[94:95], v[38:39], v[112:113]
v_mfma_f32_16x16x16_bf16 v[108:111], v[18:19], v[78:79], v[108:111]
v_pk_fma_f32 v[114:115], v[90:91], v[38:39], v[114:115] neg_lo:[1,0,0] neg_hi:[1,0,0]
v_cvt_pk_bf16_f32 v14, v112, v114
v_mfma_f32_16x16x32_bf16 v[80:83], v[40:43], v[8:11], 0
v_cvt_pk_bf16_f32 v15, v113, v115
v_pk_mul_f32 v[112:113], v[96:97], v[24:25]
v_mfma_f32_16x16x32_bf16 v[84:87], v[44:47], v[8:11], 0
v_pk_mul_f32 v[114:115], v[100:101], v[24:25]
v_pk_fma_f32 v[112:113], v[100:101], v[32:33], v[112:113]
v_mfma_f32_16x16x32_bf16 v[88:91], v[40:43], v[12:15], 0
v_pk_fma_f32 v[114:115], v[96:97], v[32:33], v[114:115] neg_lo:[1,0,0] neg_hi:[1,0,0]
v_cvt_pk_bf16_f32 v16, v112, v114
v_mfma_f32_16x16x32_bf16 v[92:95], v[44:47], v[12:15], 0
v_cvt_pk_bf16_f32 v17, v113, v115
v_pk_mul_f32 v[112:113], v[98:99], v[26:27]
v_pk_mul_f32 v[114:115], v[102:103], v[26:27]
v_pk_fma_f32 v[112:113], v[102:103], v[34:35], v[112:113]
v_pk_fma_f32 v[114:115], v[98:99], v[34:35], v[114:115] neg_lo:[1,0,0] neg_hi:[1,0,0]
v_cvt_pk_bf16_f32 v18, v112, v114
v_cvt_pk_bf16_f32 v19, v113, v115
v_pk_mul_f32 v[112:113], v[104:105], v[28:29]
v_pk_mul_f32 v[114:115], v[108:109], v[28:29]
v_mfma_f32_16x16x32_bf16 v[96:99], v[40:43], v[16:19], 0
v_pk_fma_f32 v[112:113], v[108:109], v[36:37], v[112:113]
v_pk_fma_f32 v[114:115], v[104:105], v[36:37], v[114:115] neg_lo:[1,0,0] neg_hi:[1,0,0]
v_mfma_f32_16x16x32_bf16 v[100:103], v[44:47], v[16:19], 0
v_cvt_pk_bf16_f32 v20, v112, v114
v_cvt_pk_bf16_f32 v21, v113, v115
v_pk_mul_f32 v[112:113], v[106:107], v[30:31]
v_pk_mul_f32 v[114:115], v[110:111], v[30:31]
v_pk_fma_f32 v[112:113], v[110:111], v[38:39], v[112:113]
v_pk_fma_f32 v[114:115], v[106:107], v[38:39], v[114:115] neg_lo:[1,0,0] neg_hi:[1,0,0]
v_cvt_pk_bf16_f32 v22, v112, v114
v_cvt_pk_bf16_f32 v23, v113, v115
s_nop 1
v_mfma_f32_16x16x32_bf16 v[104:107], v[40:43], v[20:23], 0
v_mfma_f32_16x16x32_bf16 v[108:111], v[44:47], v[20:23], 0
s_lshl_b32 s73, s60, 12
s_sub_u32 s70, 8, s60
v_cmp_gt_u32 vcc, 5, v2
s_cmp_eq_u32 s60, 0
s_cselect_b32 s70, 4, s70
s_lshl_b32 s71, s60, 8
v_lshlrev_b32 v52, 2, v1
s_add_u32 s71, s71, s3
v_mul_u32_u24 v50, 336, v3
v_lshlrev_b32 v51, 2, v2
v_add_u32 v52, s73, v52
s_mul_i32 s71, s71, 1344
s_lshl_b32 s72, s70, 8
v_add_u32 v50, v50, v51
v_add_u32 v52, 1344, v52
s_add_u32 s72, s72, s3
v_add_u32 v50, s73, v50
v_subrev_u32 v52, 64, v52
s_mul_i32 s72, s72, 1344
v_cndmask_b32 v52, v52, v50, vcc
s_cmp_eq_u32 s60, 0
s_nop 0
s_cbranch_scc1 P1_W0
v_pk_add_f32 v[112:113], v[80:81], v[100:101] neg_lo:[0,1] neg_hi:[0,1]
v_pk_add_f32 v[114:115], v[84:85], v[96:97]
v_pk_add_f32 v[116:117], v[80:81], v[100:101]
v_pk_add_f32 v[118:119], v[84:85], v[96:97] neg_lo:[0,1] neg_hi:[0,1]
v_cvt_pk_bf16_f32 v24, v112, v114
v_cvt_pk_bf16_f32 v40, v116, v118
v_cvt_pk_bf16_f32 v25, v113, v115
v_cvt_pk_bf16_f32 v41, v117, v119
v_pk_add_f32 v[112:113], v[82:83], v[102:103] neg_lo:[0,1] neg_hi:[0,1]
v_pk_add_f32 v[114:115], v[86:87], v[98:99]
v_pk_add_f32 v[116:117], v[82:83], v[102:103]
v_pk_add_f32 v[118:119], v[86:87], v[98:99] neg_lo:[0,1] neg_hi:[0,1]
v_cvt_pk_bf16_f32 v26, v112, v114
v_cvt_pk_bf16_f32 v42, v116, v118
v_cvt_pk_bf16_f32 v27, v113, v115
v_cvt_pk_bf16_f32 v43, v117, v119
v_pk_add_f32 v[112:113], v[88:89], v[108:109] neg_lo:[0,1] neg_hi:[0,1]
v_pk_add_f32 v[114:115], v[92:93], v[104:105]
v_pk_add_f32 v[116:117], v[88:89], v[108:109]
v_pk_add_f32 v[118:119], v[92:93], v[104:105] neg_lo:[0,1] neg_hi:[0,1]
v_cvt_pk_bf16_f32 v28, v112, v114
v_cvt_pk_bf16_f32 v44, v116, v118
v_cvt_pk_bf16_f32 v29, v113, v115
v_cvt_pk_bf16_f32 v45, v117, v119
v_pk_add_f32 v[112:113], v[90:91], v[110:111] neg_lo:[0,1] neg_hi:[0,1]
v_pk_add_f32 v[114:115], v[94:95], v[106:107]
v_pk_add_f32 v[116:117], v[90:91], v[110:111]
v_pk_add_f32 v[118:119], v[94:95], v[106:107] neg_lo:[0,1] neg_hi:[0,1]
v_cvt_pk_bf16_f32 v30, v112, v114
v_cvt_pk_bf16_f32 v46, v116, v118
v_cvt_pk_bf16_f32 v31, v113, v115
v_cvt_pk_bf16_f32 v47, v117, v119
s_nop 1
s_branch P1_ST
P1_W0:
v_cvt_pk_bf16_f32 v24, v80, v84
v_cvt_pk_bf16_f32 v25, v81, v85
v_cvt_pk_bf16_f32 v26, v82, v86
v_cvt_pk_bf16_f32 v27, v83, v87
v_cvt_pk_bf16_f32 v28, v88, v92
v_cvt_pk_bf16_f32 v29, v89, v93
v_cvt_pk_bf16_f32 v30, v90, v94
v_cvt_pk_bf16_f32 v31, v91, v95
v_cvt_pk_bf16_f32 v40, v96, v100
v_cvt_pk_bf16_f32 v41, v97, v101
v_cvt_pk_bf16_f32 v42, v98, v102
v_cvt_pk_bf16_f32 v43, v99, v103
v_cvt_pk_bf16_f32 v44, v104, v108
v_cvt_pk_bf16_f32 v45, v105, v109
v_cvt_pk_bf16_f32 v46, v106, v110
v_cvt_pk_bf16_f32 v47, v107, v111
s_nop 1
P1_ST:
ds_write_b32 v50, v24 offset:0
ds_write_b32 v50, v25 offset:84
ds_write_b32 v50, v26 offset:168
v_and_b32 v55, 31, v1
v_lshrrev_b32 v56, 5, v1
s_lshl_b32 s73, s60, 12
ds_write_b32 v50, v27 offset:252
v_lshlrev_b32 v53, 4, v1
v_lshlrev_b32 v57, 4, v55
v_lshlrev_b32 v58, 11, v56
ds_write_b32 v52, v28 offset:64
v_add_u32 v54, s73, v53
v_add3_u32 v57, v57, v58, s73
v_cmp_gt_u32 vcc, 20, v55
ds_write_b32 v52, v29 offset:148
v_lshlrev_b32 v59, 4, v55
s_sub_u32 s74, s72, s71
v_add_u32 v59, 1024, v59
ds_write_b32 v52, v30 offset:232
v_mul_lo_u32 v60, v56, s74
v_mov_b32 v58, v53
v_add_u32 v59, v59, v60
ds_write_b32 v52, v31 offset:316
v_add_u32 v59, s71, v59
v_mov_b32 v60, 0x80000000
v_cndmask_b32 v59, v60, v59, vcc
ds_write_b32 v50, v40 offset:2048
ds_write_b32 v50, v41 offset:2132
ds_write_b32 v50, v42 offset:2216
ds_write_b32 v50, v43 offset:2300
ds_write_b32 v52, v44 offset:2112
ds_write_b32 v52, v45 offset:2196
ds_write_b32 v52, v46 offset:2280
ds_write_b32 v52, v47 offset:2364
ds_read_b128 v[80:83], v54
ds_read_b128 v[84:87], v54 offset:2048
ds_read_b128 v[88:91], v57 offset:1024
s_waitcnt lgkmcnt(2)
buffer_store_dwordx4 v[80:83], v58, s[48:51], s71 offen sc1
s_waitcnt lgkmcnt(1)
buffer_store_dwordx4 v[84:87], v58, s[48:51], s72 offen sc1
s_waitcnt lgkmcnt(0)
buffer_store_dwordx4 v[88:91], v59, s[48:51], 0 offen sc1
s_endpgm
s_nop 0
k1_kernel_UT:
s_sub_u32 s3, s2, 576
s_mov_b32 s44, s16
s_mov_b32 s45, s17
s_and_b32 s45, s45, 0xffff
s_mov_b32 s46, 0x280000
s_mov_b32 s47, 0x20000
s_add_u32 s48, s40, 0x600000
s_addc_u32 s49, s41, 0
s_and_b32 s49, s49, 0xffff
s_mov_b32 s50, 0x280000
s_mov_b32 s51, 0x20000
v_lshrrev_b32 v1, 3, v0
v_and_b32 v2, 7, v0
v_mul_u32_u24 v3, 2560, v1
v_lshlrev_b32 v4, 4, v2
v_add_u32 v3, v3, v4
s_mul_i32 s60, s3, 2
s_mul_hi_u32 s52, s60, 0x1999999a
s_mul_i32 s53, s52, 10
s_sub_u32 s53, s60, s53
s_mul_i32 s54, s52, 81920
s_lshl_b32 s55, s53, 7
s_add_u32 s54, s54, s55
s_mul_i32 s62, s53, 262144
s_lshl_b32 s55, s52, 7
s_add_u32 s62, s62, s55
buffer_load_dwordx4 v[8:11], v3, s[44:47], s54 offen
s_add_u32 s57, s54, 1280
buffer_load_dwordx4 v[12:15], v3, s[44:47], s57 offen
s_mul_i32 s60, s3, 2
s_add_u32 s60, s60, 1
s_mul_hi_u32 s52, s60, 0x1999999a
s_mul_i32 s53, s52, 10
s_sub_u32 s53, s60, s53
s_mul_i32 s54, s52, 81920
s_lshl_b32 s55, s53, 7
s_add_u32 s54, s54, s55
s_mul_i32 s63, s53, 262144
s_lshl_b32 s55, s52, 7
s_add_u32 s63, s63, s55
buffer_load_dwordx4 v[16:19], v3, s[44:47], s54 offen
s_add_u32 s57, s54, 1280
buffer_load_dwordx4 v[20:23], v3, s[44:47], s57 offen
v_lshrrev_b32 v4, 2, v1
v_xor_b32 v4, v4, v2
v_lshlrev_b32 v4, 4, v4
v_and_b32 v5, 3, v1
v_lshlrev_b32 v5, 2, v5
v_add_u32 v4, v4, v5
v_lshlrev_b32 v5, 10, v2
v_add_u32 v4, v4, v5
v_lshrrev_b32 v5, 3, v1
v_xor_b32 v6, v5, v2
v_lshlrev_b32 v6, 4, v6
v_lshlrev_b32 v7, 7, v1
v_add_u32 v6, v6, v7
v_add_u32 v5, 4, v5
v_xor_b32 v5, v5, v2
v_lshlrev_b32 v5, 4, v5
v_add_u32 v5, v5, v7
v_mul_u32_u24 v7, 4096, v1
v_lshlrev_b32 v24, 4, v2
v_add_u32 v7, v7, v24
s_mov_b32 s58, 0x05040100
s_mov_b32 s59, 0x07060302
s_waitcnt vmcnt(2)
v_perm_b32 v24, v12, v8, s58
v_perm_b32 v25, v12, v8, s59
v_perm_b32 v26, v13, v9, s58
v_perm_b32 v27, v13, v9, s59
v_perm_b32 v28, v14, v10, s58
v_perm_b32 v29, v14, v10, s59
v_perm_b32 v30, v15, v11, s58
v_perm_b32 v31, v15, v11, s59
ds_write_b32 v4, v24 offset:0
ds_write_b32 v4, v25 offset:128
ds_write_b32 v4, v26 offset:256
ds_write_b32 v4, v27 offset:384
ds_write_b32 v4, v28 offset:512
ds_write_b32 v4, v29 offset:640
ds_write_b32 v4, v30 offset:768
ds_write_b32 v4, v31 offset:896
s_waitcnt vmcnt(0)
v_perm_b32 v24, v20, v16, s58
v_perm_b32 v25, v20, v16, s59
v_perm_b32 v26, v21, v17, s58
v_perm_b32 v27, v21, v17, s59
v_perm_b32 v28, v22, v18, s58
v_perm_b32 v29, v22, v18, s59
v_perm_b32 v30, v23, v19, s58
v_perm_b32 v31, v23, v19, s59
ds_write_b32 v4, v24 offset:8192
ds_write_b32 v4, v25 offset:8320
ds_write_b32 v4, v26 offset:8448
ds_write_b32 v4, v27 offset:8576
ds_write_b32 v4, v28 offset:8704
ds_write_b32 v4, v29 offset:8832
ds_write_b32 v4, v30 offset:8960
ds_write_b32 v4, v31 offset:9088
s_waitcnt lgkmcnt(0)
s_barrier
ds_read_b128 v[8:11], v6 offset:0
ds_read_b128 v[12:15], v5 offset:4096
ds_read_b128 v[16:19], v6 offset:8192
ds_read_b128 v[20:23], v5 offset:12288
s_add_u32 s57, s62, 131072
s_waitcnt lgkmcnt(3)
buffer_store_dwordx4 v[8:11], v7, s[48:51], s62 offen sc1
s_waitcnt lgkmcnt(2)
buffer_store_dwordx4 v[12:15], v7, s[48:51], s57 offen sc1
s_add_u32 s57, s63, 131072
s_waitcnt lgkmcnt(1)
buffer_store_dwordx4 v[16:19], v7, s[48:51], s63 offen sc1
s_waitcnt lgkmcnt(0)
buffer_store_dwordx4 v[20:23], v7, s[48:51], s57 offen sc1
s_endpgm
s_nop 0
k1_kernel_TB:
v_lshrrev_b32 v4, 6, v0
s_sub_u32 s3, s2, 736
v_readfirstlane_b32 s60, v4
s_add_u32 s44, s40, 0xe00000
s_addc_u32 s45, s41, 0
v_and_b32 v1, 63, v0
s_and_b32 s45, s45, 0xffff
s_mov_b32 s46, 0x47c00
s_mov_b32 s47, 0x20000
s_and_b32 s61, s60, 1
s_lshr_b32 s62, s60, 1
v_lshrrev_b32 v3, 4, v1
s_lshl_b32 s63, s62, 1
v_lshlrev_b32 v22, 3, v3
s_add_u32 s63, s63, 2
v_and_b32 v2, 15, v1
s_sub_u32 s63, s63, s61
s_lshl_b32 s64, s61, 2
s_cmp_eq_u32 s62, 0
s_cselect_b32 s64, s64, 0
v_subrev_u32 v22, 8, v22
s_add_u32 s64, s64, s63
v_sub_u32 v22, v2, v22
s_lshl_b32 s65, s63, 1
v_add_u32 v22, s64, v22
v_mov_b32 v25, 0x3f80
v_subrev_u32 v24, 0, v22
s_lshl_b32 s63, s60, 10
v_cmp_ge_u32 vcc, s65, v24
v_subrev_u32 v24, 1, v22
v_lshlrev_b32 v10, 4, v1
s_add_u32 s63, s63, 289792
v_cndmask_b32 v26, 0, v25, vcc
v_cmp_ge_u32 vcc, s65, v24
v_mov_b32 v25, 0x3f800000
v_subrev_u32 v24, 2, v22
v_cndmask_b32 v27, 0, v25, vcc
v_cmp_ge_u32 vcc, s65, v24
v_mov_b32 v25, 0x3f80
v_subrev_u32 v24, 3, v22
v_or_b32 v12, v26, v27
v_cndmask_b32 v26, 0, v25, vcc
v_cmp_ge_u32 vcc, s65, v24
v_mov_b32 v25, 0x3f800000
v_subrev_u32 v24, 4, v22
v_cndmask_b32 v27, 0, v25, vcc
v_cmp_ge_u32 vcc, s65, v24
v_mov_b32 v25, 0x3f80
v_subrev_u32 v24, 5, v22
v_or_b32 v13, v26, v27
v_cndmask_b32 v26, 0, v25, vcc
v_cmp_ge_u32 vcc, s65, v24
v_mov_b32 v25, 0x3f800000
v_subrev_u32 v24, 6, v22
v_cndmask_b32 v27, 0, v25, vcc
v_cmp_ge_u32 vcc, s65, v24
v_mov_b32 v25, 0x3f80
v_subrev_u32 v24, 7, v22
v_or_b32 v14, v26, v27
v_cndmask_b32 v26, 0, v25, vcc
v_cmp_ge_u32 vcc, s65, v24
v_mov_b32 v25, 0x3f800000
s_nop 0
v_cndmask_b32 v27, 0, v25, vcc
v_or_b32 v15, v26, v27
buffer_store_dwordx4 v[12:15], v10, s[44:47], s63 offen sc1
s_endpgm
s_nop 0
k1_kernel_PF:
s_sub_u32 s3, s2, 737
s_mov_b32 s44, s32
s_mov_b32 s45, s33
s_and_b32 s45, s45, 0xffff
s_mov_b32 s46, 0x141000
s_mov_b32 s47, 0x20000
s_mov_b32 s48, s34
s_mov_b32 s49, s35
s_and_b32 s49, s49, 0xffff
s_mov_b32 s50, 0x141000
s_mov_b32 s51, 0x20000
v_lshlrev_b32 v1, 4, v0
s_mul_i32 s61, s3, 16384
s_add_u32 s62, s61, 0
buffer_load_dwordx4 v[8:11], v1, s[44:47], s62 offen
buffer_load_dwordx4 v[12:15], v1, s[48:51], s62 offen
s_add_u32 s62, s61, 4096
buffer_load_dwordx4 v[16:19], v1, s[44:47], s62 offen
buffer_load_dwordx4 v[20:23], v1, s[48:51], s62 offen
s_add_u32 s62, s61, 8192
buffer_load_dwordx4 v[24:27], v1, s[44:47], s62 offen
buffer_load_dwordx4 v[28:31], v1, s[48:51], s62 offen
s_add_u32 s62, s61, 12288
buffer_load_dwordx4 v[32:35], v1, s[44:47], s62 offen
buffer_load_dwordx4 v[36:39], v1, s[48:51], s62 offen
s_waitcnt vmcnt(0)
s_endpgm
.globl k2_kernel
.p2align 8
.type k2_kernel,@function
k2_kernel:
s_load_dwordx16 s[16:31], s[0:1], 0
s_load_dwordx8 s[32:39], s[0:1], 64
s_load_dwordx2 s[40:41], s[0:1], 96
s_waitcnt lgkmcnt(0)
s_cmp_lt_u32 s2, 256
s_cbranch_scc1 k2_kernel_CVa
s_cmp_lt_u32 s2, 424
s_cbranch_scc1 k2_kernel_P2
s_cmp_lt_u32 s2, 488
s_cbranch_scc1 k2_kernel_CVb
s_endpgm
k2_kernel_CVa:
s_sub_u32 s3, s2, 0
s_branch CV_BODY
k2_kernel_P2:
s_sub_u32 s3, s2, 256
s_and_b32 s4, s3, 7
s_lshr_b32 s5, s3, 3
s_mov_b32 s44, s40
s_mov_b32 s45, s41
s_and_b32 s45, s45, 0xffff
s_mov_b32 s46, 0x2a0000
s_mov_b32 s47, 0x20000
s_mov_b32 s48, s40
s_mov_b32 s49, s41
s_and_b32 s49, s49, 0xffff
s_mov_b32 s50, 0x2a0000
s_mov_b32 s51, 0x20000
v_and_b32 v1, 63, v0
v_and_b32 v2, 15, v1
v_lshrrev_b32 v3, 4, v1
v_lshrrev_b32 v4, 6, v0
s_nop 0
v_readfirstlane_b32 s60, v4
s_mov_b32 s61, s4
s_mov_b32 s62, s5
s_lshl_b32 s72, s61, 8
s_nop 0
s_lshl_b32 s73, s60, 2
s_add_u32 s72, s72, s73
s_mul_i32 s72, s72, 1344
s_lshl_b32 s73, s62, 6
s_add_u32 s72, s72, s73
s_add_u32 s73, s72, 21504
s_add_u32 s74, s72, 43008
s_add_u32 s75, s72, 64512
v_mul_u32_u24 v5, 86016, v3
v_lshlrev_b32 v6, 2, v2
v_add_u32 v5, v5, v6
s_mul_i32 s82, s61, 21
s_add_u32 s82, s82, s62
s_lshl_b32 s82, s82, 14
s_lshl_b32 s83, s60, 8
s_add_u32 s82, s82, s83
v_lshlrev_b32 v7, 12, v3
v_lshl_add_u32 v7, v2, 2, v7
buffer_load_dword v8, v5, s[44:47], s72 offen offset:0
buffer_load_dword v9, v5, s[44:47], s73 offen offset:0
buffer_load_dword v10, v5, s[44:47], s74 offen offset:0
buffer_load_dword v11, v5, s[44:47], s75 offen offset:0
buffer_load_dword v12, v5, s[44:47], s72 offen offset:1344
buffer_load_dword v13, v5, s[44:47], s73 offen offset:1344
buffer_load_dword v14, v5, s[44:47], s74 offen offset:1344
buffer_load_dword v15, v5, s[44:47], s75 offen offset:1344
buffer_load_dword v16, v5, s[44:47], s72 offen offset:2688
buffer_load_dword v17, v5, s[44:47], s73 offen offset:2688
buffer_load_dword v18, v5, s[44:47], s74 offen offset:2688
buffer_load_dword v19, v5, s[44:47], s75 offen offset:2688
buffer_load_dword v20, v5, s[44:47], s72 offen offset:4032
buffer_load_dword v21, v5, s[44:47], s73 offen offset:4032
buffer_load_dword v22, v5, s[44:47], s74 offen offset:4032
buffer_load_dword v23, v5, s[44:47], s75 offen offset:4032
s_mov_b32 s64, s32
s_mov_b32 s65, s33
s_and_b32 s65, s65, 0xffff
s_mov_b32 s66, 0x141000
s_mov_b32 s67, 0x20000
s_mov_b32 s68, s34
s_mov_b32 s69, s35
s_and_b32 s69, s69, 0xffff
s_mov_b32 s70, 0x141000
s_mov_b32 s71, 0x20000
s_lshl_b32 s78, s62, 4
v_add_u32 v7, s78, v2
v_mul_u32_u24 v200, 3121, v7
v_lshrrev_b32 v200, 16, v200
v_mul_u32_u24 v201, 19, v200
v_add_u32 v7, v7, v201
v_cmp_le_u32 vcc, 8, v200
v_sub_u32 v200, 640, v7
s_nop 0
v_cndmask_b32 v7, v7, v200, vcc
v_lshlrev_b32 v7, 1, v7
v_mul_u32_u24 v201, 328704, v3
v_add_u32 v201, v201, v7
s_lshl_b32 s78, s60, 5
s_add_u32 s78, s78, s61
s_mul_i32 s78, s78, 642
v_cvt_f32_u32 v210, s61
s_lshl_b32 s83, s60, 5
s_add_u32 s83, s83, s61
v_cvt_f32_u32 v211, s83
v_mul_u32_u24 v208, 5120, v3
v_mul_u32_u24 v209, 80, v2
v_add_u32 v208, v208, v209
s_lshl_b32 s81, s60, 4
v_add_u32 v208, s81, v208
s_mul_i32 s81, s60, 5120
v_lshlrev_b32 v106, 4, v3
v_add_u32 v209, v209, v106
v_add_u32 v209, s81, v209
s_add_u32 s79, s78, 0
v_mov_b32 v112, 0
v_mov_b32 v184, 0
buffer_load_short_d16_hi v112, v201, s[64:67], s79 offen
buffer_load_short_d16_hi v184, v201, s[68:71], s79 offen
v_cvt_f32_u32 v104, v2
v_lshlrev_b32 v105, 2, v3
v_cvt_f32_u32 v105, v105
v_fmamk_f32 v106, v104, 0x41000000, v210
v_mul_f32 v106, 0x3c000000, v106
v_mul_f32 v107, v105, v106
v_cos_f32 v109, v107
v_sin_f32 v110, v107
s_nop 0
v_cvt_pk_bf16_f32 v24, v109, v110
v_cvt_pk_bf16_f32 v28, -v110, v109
s_add_u32 s79, s78, 82176
v_mov_b32 v113, 0
v_mov_b32 v185, 0
buffer_load_short_d16_hi v113, v201, s[64:67], s79 offen
buffer_load_short_d16_hi v185, v201, s[68:71], s79 offen
v_fmamk_f32 v111, v106, 0x3f800000, v107
v_cos_f32 v212, v111
v_sin_f32 v213, v111
s_nop 0
v_cvt_pk_bf16_f32 v25, v212, v213
v_cvt_pk_bf16_f32 v29, -v213, v212
v_fmamk_f32 v108, v106, 0x40000000, v107
v_cos_f32 v109, v108
v_sin_f32 v110, v108
s_nop 0
v_cvt_pk_bf16_f32 v26, v109, v110
v_cvt_pk_bf16_f32 v30, -v110, v109
v_fmamk_f32 v111, v106, 0x40400000, v107
v_cos_f32 v212, v111
s_add_u32 s79, s78, 164352
v_mov_b32 v114, 0
v_mov_b32 v186, 0
buffer_load_short_d16_hi v114, v201, s[64:67], s79 offen
buffer_load_short_d16_hi v186, v201, s[68:71], s79 offen
v_sin_f32 v213, v111
s_nop 0
v_cvt_pk_bf16_f32 v27, v212, v213
v_cvt_pk_bf16_f32 v31, -v213, v212
v_fmamk_f32 v106, v104, 0x43000000, v211
v_mul_f32 v106, 0x3a000000, v106
v_mul_f32 v107, v105, v106
v_cos_f32 v109, v107
v_sin_f32 v110, v107
s_nop 0
v_cvt_pk_bf16_f32 v40, v109, v110
v_cvt_pk_bf16_f32 v44, -v110, v109
v_fmamk_f32 v111, v106, 0x3f800000, v107
v_cos_f32 v212, v111
s_add_u32 s79, s78, 246528
v_mov_b32 v115, 0
v_mov_b32 v187, 0
buffer_load_short_d16_hi v115, v201, s[64:67], s79 offen
buffer_load_short_d16_hi v187, v201, s[68:71], s79 offen
v_sin_f32 v213, v111
s_nop 0
v_cvt_pk_bf16_f32 v41, v212, v213
v_cvt_pk_bf16_f32 v45, -v213, v212
v_fmamk_f32 v108, v106, 0x40000000, v107
v_cos_f32 v109, v108
v_sin_f32 v110, v108
s_nop 0
v_cvt_pk_bf16_f32 v42, v109, v110
v_cvt_pk_bf16_f32 v46, -v110, v109
v_fmamk_f32 v111, v106, 0x40400000, v107
v_cos_f32 v212, v111
v_sin_f32 v213, v111
s_add_u32 s79, s78, 5136
v_mov_b32 v116, 0
v_mov_b32 v188, 0
buffer_load_short_d16_hi v116, v201, s[64:67], s79 offen
buffer_load_short_d16_hi v188, v201, s[68:71], s79 offen
v_cvt_pk_bf16_f32 v43, v212, v213
v_cvt_pk_bf16_f32 v47, -v213, v212
v_fmamk_f32 v106, v104, 0x43000000, v211
v_add_f32 v106, 0x41000000, v106
v_mul_f32 v106, 0x3a000000, v106
v_mul_f32 v107, v105, v106
v_cos_f32 v109, v107
v_sin_f32 v110, v107
s_nop 0
v_cvt_pk_bf16_f32 v48, v109, v110
v_cvt_pk_bf16_f32 v52, -v110, v109
v_fmamk_f32 v111, v106, 0x3f800000, v107
v_cos_f32 v212, v111
s_add_u32 s79, s78, 87312
v_mov_b32 v117, 0
v_mov_b32 v189, 0
buffer_load_short_d16_hi v117, v201, s[64:67], s79 offen
buffer_load_short_d16_hi v189, v201, s[68:71], s79 offen
v_sin_f32 v213, v111
s_nop 0
v_cvt_pk_bf16_f32 v49, v212, v213
v_cvt_pk_bf16_f32 v53, -v213, v212
v_fmamk_f32 v108, v106, 0x40000000, v107
v_cos_f32 v109, v108
v_sin_f32 v110, v108
s_nop 0
v_cvt_pk_bf16_f32 v50, v109, v110
v_cvt_pk_bf16_f32 v54, -v110, v109
v_fmamk_f32 v111, v106, 0x40400000, v107
v_cos_f32 v212, v111
v_sin_f32 v213, v111
s_nop 0
v_cvt_pk_bf16_f32 v51, v212, v213
s_add_u32 s79, s78, 169488
v_mov_b32 v118, 0
v_mov_b32 v190, 0
buffer_load_short_d16_hi v118, v201, s[64:67], s79 offen
buffer_load_short_d16_hi v190, v201, s[68:71], s79 offen
v_cvt_pk_bf16_f32 v55, -v213, v212
v_fmamk_f32 v106, v104, 0x43000000, v211
v_add_f32 v106, 0x41800000, v106
v_mul_f32 v106, 0x3a000000, v106
v_mul_f32 v107, v105, v106
v_cos_f32 v109, v107
v_sin_f32 v110, v107
s_nop 0
v_cvt_pk_bf16_f32 v56, v109, v110
v_cvt_pk_bf16_f32 v60, -v110, v109
v_fmamk_f32 v111, v106, 0x3f800000, v107
v_cos_f32 v212, v111
s_add_u32 s79, s78, 251664
v_mov_b32 v119, 0
v_mov_b32 v191, 0
buffer_load_short_d16_hi v119, v201, s[64:67], s79 offen
buffer_load_short_d16_hi v191, v201, s[68:71], s79 offen
v_sin_f32 v213, v111
s_nop 0
v_cvt_pk_bf16_f32 v57, v212, v213
v_cvt_pk_bf16_f32 v61, -v213, v212
v_fmamk_f32 v108, v106, 0x40000000, v107
v_cos_f32 v109, v108
v_sin_f32 v110, v108
s_nop 0
v_cvt_pk_bf16_f32 v58, v109, v110
v_cvt_pk_bf16_f32 v62, -v110, v109
v_fmamk_f32 v111, v106, 0x40400000, v107
v_cos_f32 v212, v111
v_sin_f32 v213, v111
s_nop 0
v_cvt_pk_bf16_f32 v59, v212, v213
s_add_u32 s79, s78, 10272
v_mov_b32 v120, 0
v_mov_b32 v192, 0
buffer_load_short_d16_hi v120, v201, s[64:67], s79 offen
buffer_load_short_d16_hi v192, v201, s[68:71], s79 offen
v_cvt_pk_bf16_f32 v63, -v213, v212
v_fmamk_f32 v106, v104, 0x43000000, v211
v_add_f32 v106, 0x41c00000, v106
v_mul_f32 v106, 0x3a000000, v106
v_mul_f32 v107, v105, v106
v_cos_f32 v109, v107
v_sin_f32 v110, v107
s_nop 0
v_cvt_pk_bf16_f32 v64, v109, v110
v_cvt_pk_bf16_f32 v68, -v110, v109
v_fmamk_f32 v111, v106, 0x3f800000, v107
v_cos_f32 v212, v111
v_sin_f32 v213, v111
s_add_u32 s79, s78, 92448
v_mov_b32 v121, 0
v_mov_b32 v193, 0
buffer_load_short_d16_hi v121, v201, s[64:67], s79 offen
buffer_load_short_d16_hi v193, v201, s[68:71], s79 offen
v_cvt_pk_bf16_f32 v65, v212, v213
v_cvt_pk_bf16_f32 v69, -v213, v212
v_fmamk_f32 v108, v106, 0x40000000, v107
v_cos_f32 v109, v108
v_sin_f32 v110, v108
s_nop 0
v_cvt_pk_bf16_f32 v66, v109, v110
v_cvt_pk_bf16_f32 v70, -v110, v109
v_fmamk_f32 v111, v106, 0x40400000, v107
v_cos_f32 v212, v111
v_sin_f32 v213, v111
s_nop 0
v_cvt_pk_bf16_f32 v67, v212, v213
v_cvt_pk_bf16_f32 v71, -v213, v212
s_waitcnt vmcnt(32)
v_mfma_f32_16x16x32_bf16 v[136:139], v[24:27], v[8:11], 0
v_mfma_f32_16x16x32_bf16 v[140:143], v[28:31], v[8:11], 0
s_waitcnt vmcnt(28)
v_mfma_f32_16x16x32_bf16 v[144:147], v[24:27], v[12:15], 0
v_mfma_f32_16x16x32_bf16 v[148:151], v[28:31], v[12:15], 0
s_waitcnt vmcnt(24)
v_mfma_f32_16x16x32_bf16 v[152:155], v[24:27], v[16:19], 0
v_mfma_f32_16x16x32_bf16 v[156:159], v[28:31], v[16:19], 0
s_waitcnt vmcnt(20)
v_mfma_f32_16x16x32_bf16 v[160:163], v[24:27], v[20:23], 0
v_mfma_f32_16x16x32_bf16 v[164:167], v[28:31], v[20:23], 0
v_cvt_pk_bf16_f32 v168, v136, v140
v_cvt_pk_bf16_f32 v172, v137, v141
v_cvt_pk_bf16_f32 v176, v138, v142
v_cvt_pk_bf16_f32 v180, v139, v143
v_cvt_pk_bf16_f32 v169, v144, v148
v_cvt_pk_bf16_f32 v173, v145, v149
v_cvt_pk_bf16_f32 v177, v146, v150
v_cvt_pk_bf16_f32 v181, v147, v151
v_cvt_pk_bf16_f32 v170, v152, v156
v_cvt_pk_bf16_f32 v174, v153, v157
v_cvt_pk_bf16_f32 v178, v154, v158
v_cvt_pk_bf16_f32 v182, v155, v159
v_cvt_pk_bf16_f32 v171, v160, v164
v_cvt_pk_bf16_f32 v175, v161, v165
v_cvt_pk_bf16_f32 v179, v162, v166
v_cvt_pk_bf16_f32 v183, v163, v167
ds_write_b128 v208, v[168:171] offset:0
ds_write_b128 v208, v[172:175] offset:1280
ds_write_b128 v208, v[176:179] offset:2560
ds_write_b128 v208, v[180:183] offset:3840
s_add_u32 s79, s78, 174624
v_mov_b32 v122, 0
v_mov_b32 v194, 0
buffer_load_short_d16_hi v122, v201, s[64:67], s79 offen
buffer_load_short_d16_hi v194, v201, s[68:71], s79 offen
v_mul_f32 v106, 0x3d800000, v104
v_mov_b32 v107, v211
v_mul_f32 v107, v107, v104
v_mul_f32 v107, 0x3a000000, v107
v_fmac_f32 v107, v105, v106
v_cos_f32 v109, v107
v_sin_f32 v110, v107
s_nop 0
v_cvt_pk_bf16_f32 v72, v109, -v110
v_cvt_pk_bf16_f32 v76, v110, v109
v_fmamk_f32 v111, v106, 0x3f800000, v107
v_cos_f32 v212, v111
v_sin_f32 v213, v111
s_nop 0
v_cvt_pk_bf16_f32 v73, v212, -v213
s_add_u32 s79, s78, 256800
v_mov_b32 v123, 0
v_mov_b32 v195, 0
buffer_load_short_d16_hi v123, v201, s[64:67], s79 offen
buffer_load_short_d16_hi v195, v201, s[68:71], s79 offen
v_cvt_pk_bf16_f32 v77, v213, v212
v_fmamk_f32 v108, v106, 0x40000000, v107
v_cos_f32 v109, v108
v_sin_f32 v110, v108
s_nop 0
v_cvt_pk_bf16_f32 v74, v109, -v110
v_cvt_pk_bf16_f32 v78, v110, v109
v_fmamk_f32 v111, v106, 0x40400000, v107
v_cos_f32 v212, v111
v_sin_f32 v213, v111
s_nop 0
v_cvt_pk_bf16_f32 v75, v212, -v213
v_cvt_pk_bf16_f32 v79, v213, v212
v_mul_f32 v106, 0x3d800000, v104
v_add_f32 v107, 0x41000000, v211
s_add_u32 s79, s78, 15408
v_mov_b32 v124, 0
v_mov_b32 v196, 0
buffer_load_short_d16_hi v124, v201, s[64:67], s79 offen
buffer_load_short_d16_hi v196, v201, s[68:71], s79 offen
v_mul_f32 v107, v107, v104
v_mul_f32 v107, 0x3a000000, v107
v_fmac_f32 v107, v105, v106
v_cos_f32 v109, v107
v_sin_f32 v110, v107
s_nop 0
v_cvt_pk_bf16_f32 v80, v109, -v110
v_cvt_pk_bf16_f32 v84, v110, v109
v_fmamk_f32 v111, v106, 0x3f800000, v107
v_cos_f32 v212, v111
v_sin_f32 v213, v111
s_nop 0
v_cvt_pk_bf16_f32 v81, v212, -v213
v_cvt_pk_bf16_f32 v85, v213, v212
v_fmamk_f32 v108, v106, 0x40000000, v107
s_waitcnt lgkmcnt(0)
s_barrier
ds_read_b128 v[8:11], v209 offset:0
ds_read_b128 v[12:15], v209 offset:1280
ds_read_b128 v[16:19], v209 offset:2560
ds_read_b128 v[20:23], v209 offset:3840
s_add_u32 s79, s78, 97584
v_mov_b32 v125, 0
v_mov_b32 v197, 0
buffer_load_short_d16_hi v125, v201, s[64:67], s79 offen
buffer_load_short_d16_hi v197, v201, s[68:71], s79 offen
v_cos_f32 v109, v108
v_sin_f32 v110, v108
s_nop 0
v_cvt_pk_bf16_f32 v82, v109, -v110
v_cvt_pk_bf16_f32 v86, v110, v109
v_fmamk_f32 v111, v106, 0x40400000, v107
v_cos_f32 v212, v111
v_sin_f32 v213, v111
s_nop 0
v_cvt_pk_bf16_f32 v83, v212, -v213
v_cvt_pk_bf16_f32 v87, v213, v212
v_mul_f32 v106, 0x3d800000, v104
v_add_f32 v107, 0x41800000, v211
v_mul_f32 v107, v107, v104
v_mul_f32 v107, 0x3a000000, v107
s_add_u32 s79, s78, 179760
v_mov_b32 v126, 0
v_mov_b32 v198, 0
buffer_load_short_d16_hi v126, v201, s[64:67], s79 offen
buffer_load_short_d16_hi v198, v201, s[68:71], s79 offen
v_fmac_f32 v107, v105, v106
v_cos_f32 v109, v107
v_sin_f32 v110, v107
s_nop 0
v_cvt_pk_bf16_f32 v88, v109, -v110
v_cvt_pk_bf16_f32 v92, v110, v109
v_fmamk_f32 v111, v106, 0x3f800000, v107
v_cos_f32 v212, v111
v_sin_f32 v213, v111
s_nop 0
v_cvt_pk_bf16_f32 v89, v212, -v213
v_cvt_pk_bf16_f32 v93, v213, v212
v_fmamk_f32 v108, v106, 0x40000000, v107
v_cos_f32 v109, v108
v_sin_f32 v110, v108
s_add_u32 s79, s78, 261936
v_mov_b32 v127, 0
v_mov_b32 v199, 0
buffer_load_short_d16_hi v127, v201, s[64:67], s79 offen
buffer_load_short_d16_hi v199, v201, s[68:71], s79 offen
v_cvt_pk_bf16_f32 v90, v109, -v110
v_cvt_pk_bf16_f32 v94, v110, v109
v_fmamk_f32 v111, v106, 0x40400000, v107
v_cos_f32 v212, v111
v_sin_f32 v213, v111
s_nop 0
v_cvt_pk_bf16_f32 v91, v212, -v213
v_cvt_pk_bf16_f32 v95, v213, v212
v_mul_f32 v106, 0x3d800000, v104
v_add_f32 v107, 0x41c00000, v211
v_mul_f32 v107, v107, v104
v_mul_f32 v107, 0x3a000000, v107
v_fmac_f32 v107, v105, v106
v_cos_f32 v109, v107
s_waitcnt lgkmcnt(3)
v_mfma_f32_16x16x32_bf16 v[136:139], v[40:43], v[8:11], 0
v_fmamk_f32 v111, v106, 0x3f800000, v107
v_sin_f32 v110, v107
v_mfma_f32_16x16x32_bf16 v[140:143], v[44:47], v[8:11], 0
v_cos_f32 v212, v111
v_sin_f32 v213, v111
s_waitcnt lgkmcnt(2)
v_mfma_f32_16x16x32_bf16 v[144:147], v[48:51], v[12:15], 0
v_fmamk_f32 v108, v106, 0x40000000, v107
v_fmamk_f32 v111, v106, 0x40400000, v107
v_mfma_f32_16x16x32_bf16 v[148:151], v[52:55], v[12:15], 0
v_mul_f32 v107, v210, v104
v_mul_f32 v106, 0x3d800000, v104
s_waitcnt lgkmcnt(1)
v_mfma_f32_16x16x32_bf16 v[152:155], v[56:59], v[16:19], 0
v_mul_f32 v107, 0x3c000000, v107
v_cvt_pk_bf16_f32 v96, v109, -v110
v_mfma_f32_16x16x32_bf16 v[156:159], v[60:63], v[16:19], 0
v_fmac_f32 v107, v105, v106
v_cvt_pk_bf16_f32 v100, v110, v109
s_waitcnt lgkmcnt(0)
v_mfma_f32_16x16x32_bf16 v[160:163], v[64:67], v[20:23], 0
v_cvt_pk_bf16_f32 v97, v212, -v213
v_cvt_pk_bf16_f32 v101, v213, v212
v_mfma_f32_16x16x32_bf16 v[164:167], v[68:71], v[20:23], 0
v_cos_f32 v109, v108
v_sin_f32 v110, v108
v_cos_f32 v212, v111
v_sin_f32 v213, v111
v_fmamk_f32 v111, v106, 0x3f800000, v107
v_cvt_pk_bf16_f32 v98, v109, -v110
v_cvt_pk_bf16_f32 v102, v110, v109
v_cvt_pk_bf16_f32 v99, v212, -v213
v_cvt_pk_bf16_f32 v103, v213, v212
v_cos_f32 v109, v107
v_sin_f32 v110, v107
v_cos_f32 v212, v111
v_sin_f32 v213, v111
v_fmamk_f32 v108, v106, 0x40000000, v107
v_fmamk_f32 v111, v106, 0x40400000, v107
v_cvt_pk_bf16_f32 v32, v109, -v110
v_cvt_pk_bf16_f32 v36, v110, v109
v_cvt_pk_bf16_f32 v33, v212, -v213
v_cvt_pk_bf16_f32 v37, v213, v212
v_cos_f32 v109, v108
v_sin_f32 v110, v108
v_cos_f32 v212, v111
v_sin_f32 v213, v111
v_cvt_pk_bf16_f32 v34, v109, -v110
v_cvt_pk_bf16_f32 v38, v110, v109
v_cvt_pk_bf16_f32 v35, v212, -v213
v_cvt_pk_bf16_f32 v39, v213, v212
s_waitcnt vmcnt(29)
v_pk_mul_f32 v[128:129], v[136:137], v[112:113]
s_waitcnt vmcnt(28)
v_pk_mul_f32 v[130:131], v[136:137], v[184:185]
v_pk_fma_f32 v[128:129], v[140:141], v[184:185], v[128:129] neg_lo:[1,0,0] neg_hi:[1,0,0]
v_pk_fma_f32 v[130:131], v[140:141], v[112:113], v[130:131]
v_cvt_pk_bf16_f32 v8, v128, v130
v_cvt_pk_bf16_f32 v9, v129, v131
s_waitcnt vmcnt(25)
v_pk_mul_f32 v[128:129], v[138:139], v[114:115]
s_waitcnt vmcnt(24)
v_pk_mul_f32 v[130:131], v[138:139], v[186:187]
v_pk_fma_f32 v[128:129], v[142:143], v[186:187], v[128:129] neg_lo:[1,0,0] neg_hi:[1,0,0]
v_pk_fma_f32 v[130:131], v[142:143], v[114:115], v[130:131]
v_cvt_pk_bf16_f32 v10, v128, v130
v_cvt_pk_bf16_f32 v11, v129, v131
s_waitcnt vmcnt(21)
v_pk_mul_f32 v[128:129], v[144:145], v[116:117]
s_waitcnt vmcnt(20)
v_pk_mul_f32 v[130:131], v[144:145], v[188:189]
v_mfma_f32_16x16x32_bf16 v[136:139], v[72:75], v[8:11], 0
v_pk_fma_f32 v[128:129], v[148:149], v[188:189], v[128:129] neg_lo:[1,0,0] neg_hi:[1,0,0]
v_pk_fma_f32 v[130:131], v[148:149], v[116:117], v[130:131]
v_mfma_f32_16x16x32_bf16 v[140:143], v[76:79], v[8:11], 0
v_cvt_pk_bf16_f32 v12, v128, v130
v_cvt_pk_bf16_f32 v13, v129, v131
s_waitcnt vmcnt(17)
v_pk_mul_f32 v[128:129], v[146:147], v[118:119]
s_waitcnt vmcnt(16)
v_pk_mul_f32 v[130:131], v[146:147], v[190:191]
v_pk_fma_f32 v[128:129], v[150:151], v[190:191], v[128:129] neg_lo:[1,0,0] neg_hi:[1,0,0]
v_pk_fma_f32 v[130:131], v[150:151], v[118:119], v[130:131]
v_cvt_pk_bf16_f32 v14, v128, v130
v_cvt_pk_bf16_f32 v15, v129, v131
s_waitcnt vmcnt(13)
v_pk_mul_f32 v[128:129], v[152:153], v[120:121]
s_waitcnt vmcnt(12)
v_pk_mul_f32 v[130:131], v[152:153], v[192:193]
v_mfma_f32_16x16x32_bf16 v[144:147], v[80:83], v[12:15], 0
v_pk_fma_f32 v[128:129], v[156:157], v[192:193], v[128:129] neg_lo:[1,0,0] neg_hi:[1,0,0]
v_pk_fma_f32 v[130:131], v[156:157], v[120:121], v[130:131]
v_mfma_f32_16x16x32_bf16 v[148:151], v[84:87], v[12:15], 0
v_cvt_pk_bf16_f32 v16, v128, v130
v_cvt_pk_bf16_f32 v17, v129, v131
s_waitcnt vmcnt(9)
v_pk_mul_f32 v[128:129], v[154:155], v[122:123]
s_waitcnt vmcnt(8)
v_pk_mul_f32 v[130:131], v[154:155], v[194:195]
v_pk_fma_f32 v[128:129], v[158:159], v[194:195], v[128:129] neg_lo:[1,0,0] neg_hi:[1,0,0]
v_pk_fma_f32 v[130:131], v[158:159], v[122:123], v[130:131]
v_cvt_pk_bf16_f32 v168, v136, v140
v_cvt_pk_bf16_f32 v18, v128, v130
v_cvt_pk_bf16_f32 v19, v129, v131
s_waitcnt vmcnt(5)
v_pk_mul_f32 v[128:129], v[160:161], v[124:125]
s_waitcnt vmcnt(4)
v_pk_mul_f32 v[130:131], v[160:161], v[196:197]
v_mfma_f32_16x16x32_bf16 v[152:155], v[88:91], v[16:19], 0
v_pk_fma_f32 v[128:129], v[164:165], v[196:197], v[128:129] neg_lo:[1,0,0] neg_hi:[1,0,0]
v_pk_fma_f32 v[130:131], v[164:165], v[124:125], v[130:131]
v_mfma_f32_16x16x32_bf16 v[156:159], v[92:95], v[16:19], 0
v_cvt_pk_bf16_f32 v20, v128, v130
v_cvt_pk_bf16_f32 v21, v129, v131
s_waitcnt vmcnt(1)
v_pk_mul_f32 v[128:129], v[162:163], v[126:127]
s_waitcnt vmcnt(0)
v_pk_mul_f32 v[130:131], v[162:163], v[198:199]
v_pk_fma_f32 v[128:129], v[166:167], v[198:199], v[128:129] neg_lo:[1,0,0] neg_hi:[1,0,0]
v_pk_fma_f32 v[130:131], v[166:167], v[126:127], v[130:131]
v_cvt_pk_bf16_f32 v169, v144, v148
v_cvt_pk_bf16_f32 v22, v128, v130
v_cvt_pk_bf16_f32 v23, v129, v131
v_cvt_pk_bf16_f32 v170, v152, v156
v_cvt_pk_bf16_f32 v172, v137, v141
v_mfma_f32_16x16x32_bf16 v[160:163], v[96:99], v[20:23], 0
v_cvt_pk_bf16_f32 v173, v145, v149
v_cvt_pk_bf16_f32 v174, v153, v157
v_mfma_f32_16x16x32_bf16 v[164:167], v[100:103], v[20:23], 0
v_cvt_pk_bf16_f32 v176, v138, v142
v_cvt_pk_bf16_f32 v177, v146, v150
v_cvt_pk_bf16_f32 v178, v154, v158
v_cvt_pk_bf16_f32 v180, v139, v143
v_cvt_pk_bf16_f32 v181, v147, v151
v_cvt_pk_bf16_f32 v182, v155, v159
s_nop 1
v_cvt_pk_bf16_f32 v171, v160, v164
v_cvt_pk_bf16_f32 v175, v161, v165
v_cvt_pk_bf16_f32 v179, v162, v166
v_cvt_pk_bf16_f32 v183, v163, v167
ds_write_b128 v208, v[168:171] offset:20480
ds_write_b128 v208, v[172:175] offset:21760
ds_write_b128 v208, v[176:179] offset:23040
ds_write_b128 v208, v[180:183] offset:24320
s_waitcnt lgkmcnt(0)
s_barrier
ds_read_b128 v[8:11], v209 offset:20480
ds_read_b128 v[12:15], v209 offset:21760
ds_read_b128 v[16:19], v209 offset:23040
ds_read_b128 v[20:23], v209 offset:24320
s_waitcnt lgkmcnt(3)
v_mfma_f32_16x16x32_bf16 v[136:139], v[32:35], v[8:11], 0
v_mul_u32_u24 v208, 1088, v3
s_mul_i32 s81, s60, 4608
v_mfma_f32_16x16x32_bf16 v[140:143], v[36:39], v[8:11], 0
v_lshl_add_u32 v208, v2, 2, v208
v_mul_u32_u24 v209, 272, v3
s_waitcnt lgkmcnt(2)
v_mfma_f32_16x16x32_bf16 v[144:147], v[32:35], v[12:15], 0
v_add_u32 v208, s81, v208
v_lshl_add_u32 v209, v2, 4, v209
v_mfma_f32_16x16x32_bf16 v[148:151], v[36:39], v[12:15], 0
v_cvt_pk_bf16_f32 v168, v136, v140
v_cvt_pk_bf16_f32 v169, v137, v141
s_waitcnt lgkmcnt(1)
v_mfma_f32_16x16x32_bf16 v[152:155], v[32:35], v[16:19], 0
v_cvt_pk_bf16_f32 v170, v138, v142
v_cvt_pk_bf16_f32 v171, v139, v143
v_mfma_f32_16x16x32_bf16 v[156:159], v[36:39], v[16:19], 0
v_cvt_pk_bf16_f32 v172, v144, v148
ds_write_b32 v208, v168 offset:0
s_waitcnt lgkmcnt(1)
v_mfma_f32_16x16x32_bf16 v[160:163], v[32:35], v[20:23], 0
v_cvt_pk_bf16_f32 v173, v145, v149
ds_write_b32 v208, v169 offset:272
v_mfma_f32_16x16x32_bf16 v[164:167], v[36:39], v[20:23], 0
v_cvt_pk_bf16_f32 v174, v146, v150
ds_write_b32 v208, v170 offset:544
v_cvt_pk_bf16_f32 v175, v147, v151
ds_write_b32 v208, v171 offset:816
v_cvt_pk_bf16_f32 v176, v152, v156
ds_write_b32 v208, v172 offset:64
v_cvt_pk_bf16_f32 v177, v153, v157
ds_write_b32 v208, v173 offset:336
v_cvt_pk_bf16_f32 v178, v154, v158
v_cvt_pk_bf16_f32 v179, v155, v159
v_cvt_pk_bf16_f32 v180, v160, v164
ds_write_b32 v208, v174 offset:608
v_cvt_pk_bf16_f32 v181, v161, v165
v_cvt_pk_bf16_f32 v182, v162, v166
v_cvt_pk_bf16_f32 v183, v163, v167
ds_write_b32 v208, v175 offset:880
v_add_u32 v209, s81, v209
v_lshrrev_b32 v200, 2, v2
v_and_b32 v201, 3, v2
ds_write_b32 v208, v176 offset:128
v_lshl_add_u32 v200, v3, 4, v200
s_add_u32 s83, s72, 0
v_mul_u32_u24 v200, 1344, v200
ds_write_b32 v208, v177 offset:400
v_lshl_add_u32 v200, v201, 4, v200
ds_write_b32 v208, v178 offset:672
ds_write_b32 v208, v179 offset:944
ds_write_b32 v208, v180 offset:192
ds_write_b32 v208, v181 offset:464
ds_write_b32 v208, v182 offset:736
ds_write_b32 v208, v183 offset:1008
ds_read_b128 v[8:11], v209 offset:0
ds_read_b128 v[12:15], v209 offset:1088
ds_read_b128 v[16:19], v209 offset:2176
ds_read_b128 v[20:23], v209 offset:3264
s_waitcnt lgkmcnt(3)
buffer_store_dwordx4 v[8:11], v200, s[48:51], s83 offen sc1
s_add_u32 s83, s72, 86016
s_waitcnt lgkmcnt(2)
buffer_store_dwordx4 v[12:15], v200, s[48:51], s83 offen sc1
s_add_u32 s83, s72, 172032
s_waitcnt lgkmcnt(1)
buffer_store_dwordx4 v[16:19], v200, s[48:51], s83 offen sc1
s_add_u32 s83, s72, 258048
s_waitcnt lgkmcnt(0)
buffer_store_dwordx4 v[20:23], v200, s[48:51], s83 offen sc1
s_endpgm
s_nop 0
k2_kernel_CVb:
s_sub_u32 s3, s2, 424
s_add_u32 s3, s3, 256
CV_BODY:
s_add_u32 s44, s40, 0xc00000
s_addc_u32 s45, s41, 0
s_and_b32 s45, s45, 0xffff
s_mov_b32 s46, 0x168000
s_mov_b32 s47, 0x20000
s_add_u32 s48, s40, 0x600000
s_addc_u32 s49, s41, 0
s_and_b32 s49, s49, 0xffff
s_mov_b32 s50, 0x280000
s_mov_b32 s51, 0x20000
s_add_u32 s52, s40, 0xe00000
s_addc_u32 s53, s41, 0
s_and_b32 s53, s53, 0xffff
s_mov_b32 s54, 0x47c00
s_mov_b32 s55, 0x20000
s_add_u32 s64, s40, 0x600000
s_addc_u32 s65, s41, 0
s_and_b32 s65, s65, 0xffff
s_mov_b32 s66, 0x280000
s_mov_b32 s67, 0x20000
v_and_b32 v1, 63, v0
v_lshrrev_b32 v4, 6, v0
s_nop 0
v_readfirstlane_b32 s60, v4
s_nop 3
s_lshr_b32 s61, s60, 1
s_and_b32 s62, s60, 1
s_lshl_b32 s63, s3, 1
s_add_u32 s63, s63, s61
s_mul_i32 s68, s61, 21392
s_mul_i32 s70, s63, 2304
s_lshl_b32 s71, s63, 12
v_lshlrev_b32 v3, 3, v1
v_lshlrev_b32 v5, 4, v1
s_lshl_b32 s72, s62, 11
s_add_u32 s72, s72, s71
buffer_load_dwordx4 v[112:115], v5, s[48:51], s72 offen offset:0
buffer_load_dwordx4 v[116:119], v5, s[48:51], s72 offen offset:1024
s_lshl_b32 s73, s62, 9
s_add_u32 s73, s73, s70
buffer_load_dwordx4 v[120:123], v3, s[44:47], s73 offen offset:0
buffer_load_dwordx4 v[124:127], v3, s[44:47], s73 offen offset:1024
buffer_load_dwordx4 v[128:131], v3, s[44:47], s73 offen offset:2048
s_mov_b32 s74, 289792
buffer_load_dwordx4 v[64:67], v5, s[52:55], s74 offen offset:0
buffer_load_dwordx4 v[68:71], v5, s[52:55], s74 offen offset:1024
buffer_load_dwordx4 v[72:75], v5, s[52:55], s74 offen offset:2048
buffer_load_dwordx4 v[76:79], v5, s[52:55], s74 offen offset:3072
s_mov_b32 s81, 144
s_mov_b32 s84, 69
s_mov_b32 s85, 272
s_lshl_b32 s75, s62, 6
v_add_u32 v7, s75, v1
v_min_u32 v7, 80, v7
v_lshl_add_u32 v225, v7, 4, s68
v_and_b32 v2, 15, v1
v_lshrrev_b32 v12, 4, v1
v_and_b32 v4, 31, v1
v_lshrrev_b32 v13, 5, v1
s_add_u32 s80, s68, 8960
v_lshlrev_b32 v16, 4, v13
v_mad_u32_u24 v7, v4, s81, v16
v_add_u32 v209, s80, v7
v_lshlrev_b32 v14, 3, v13
v_sub_u32 v214, v209, v14
v_add_u32 v214, s75, v214
s_lshl_b32 s82, s62, 7
s_add_u32 s82, s82, 3728
v_lshl_add_u32 v213, v4, 7, v209
v_add_u32 v213, s82, v213
v_cmp_le_u32 vcc, 16, v4
s_add_u32 s82, s80, 1152
v_add_u32 v7, s82, v16
v_subrev_u32 v14, 1008, v209
v_cndmask_b32 v219, v7, v14, vcc
v_subrev_u32 v14, 1152, v209
v_cndmask_b32 v220, v7, v14, vcc
s_mul_i32 s82, s62, 2304
s_add_u32 s82, s82, s80
v_mov_b32 v17, s82
v_lshrrev_b32 v14, 3, v1
v_and_b32 v15, 7, v1
v_mad_u32_u24 v14, v14, s81, v17
v_lshl_add_u32 v215, v15, 4, v14
v_add_u32 v221, 1296, v215
s_lshl_b32 s82, s62, 9
s_add_u32 s82, s82, s68
v_add_u32 v222, s82, v3
v_add_u32 v223, 4480, v222
v_add_u32 v224, 6720, v222
s_mov_b32 s83, 2238
v_lshlrev_b32 v15, 2, v12
v_lshlrev_b32 v7, 1, v2
v_sub_u32 v7, v15, v7
v_add_u32 v7, 30, v7
v_and_b32 v14, 3, v7
s_add_u32 s82, s68, 1184
v_lshl_add_u32 v211, v7, 1, s82
v_mad_u32_u24 v211, v14, s83, v211
v_sub_u32 v7, v15, v2
v_add_u32 v7, 15, v7
v_and_b32 v14, 3, v7
s_add_u32 s82, s68, 1696
v_lshl_add_u32 v216, v7, 1, s82
v_mad_u32_u24 v216, v14, s83, v216
v_lshlrev_b32 v7, 3, v13
v_sub_u32 v7, v7, v4
v_add_u32 v7, 31, v7
v_and_b32 v14, 3, v7
s_add_u32 s82, s68, 0
v_lshl_add_u32 v208, v7, 1, s82
v_mad_u32_u24 v208, v14, s83, v208
v_mov_b32 v17, s80
v_add3_u32 v7, v2, v12, s84
v_lshrrev_b32 v14, 3, v7
v_and_b32 v15, 7, v7
v_mad_u32_u24 v14, v14, s81, v17
v_lshl_add_u32 v210, v15, 4, v14
v_add_u32 v7, v7, v2
v_lshrrev_b32 v14, 3, v7
v_and_b32 v15, 7, v7
v_mad_u32_u24 v14, v14, s81, v17
v_lshl_add_u32 v217, v15, 4, v14
v_add_u32 v7, 1, v7
v_lshrrev_b32 v14, 3, v7
v_and_b32 v15, 7, v7
v_mad_u32_u24 v14, v14, s81, v17
v_lshl_add_u32 v218, v15, 4, v14
v_lshrrev_b32 v7, 2, v2
v_and_b32 v14, 3, v2
v_lshlrev_b32 v14, 6, v14
v_lshl_add_u32 v14, v12, 4, v14
s_add_u32 s82, s68, 14864
v_mad_u32_u24 v7, v7, s85, v14
v_add_u32 v212, s82, v7
v_mov_b32 v8, 0
v_mov_b32 v9, 0
v_mov_b32 v10, 0
v_mov_b32 v11, 0
ds_write_b128 v225, v[8:11] offset:8960
s_nop 0
v_mov_b32 v8, 0
v_mov_b32 v9, 0
v_mov_b32 v10, 0
v_mov_b32 v11, 0
v_mov_b32 v12, 0
v_mov_b32 v13, 0
v_mov_b32 v14, 0
v_mov_b32 v15, 0
v_mov_b32 v16, 0
v_mov_b32 v17, 0
v_mov_b32 v18, 0
v_mov_b32 v19, 0
v_mov_b32 v20, 0
v_mov_b32 v21, 0
v_mov_b32 v22, 0
v_mov_b32 v23, 0
s_waitcnt vmcnt(8)
ds_write_b128 v221, v[112:115] offset:0
s_waitcnt vmcnt(7)
ds_write_b128 v221, v[116:119] offset:1152
s_waitcnt vmcnt(6)
v_alignbit_b32 v24, v121, v120, 16
v_alignbit_b32 v25, v122, v121, 16
v_alignbit_b32 v26, v123, v122, 16
ds_write_b64 v222, v[120:121] offset:0
ds_write_b64 v222, v[24:25] offset:2240
v_add_u32 v7, 0, v223
ds_write2_b32 v7, v121, v122 offset0:0 offset1:1
v_add_u32 v6, 0, v224
ds_write2_b32 v6, v25, v26 offset0:0 offset1:1
s_waitcnt vmcnt(5)
v_alignbit_b32 v28, v125, v124, 16
v_alignbit_b32 v29, v126, v125, 16
v_alignbit_b32 v30, v127, v126, 16
ds_write_b64 v222, v[124:125] offset:1024
ds_write_b64 v222, v[28:29] offset:3264
v_add_u32 v7, 1024, v223
ds_write2_b32 v7, v125, v126 offset0:0 offset1:1
v_add_u32 v6, 1024, v224
ds_write2_b32 v6, v29, v30 offset0:0 offset1:1
s_waitcnt vmcnt(4)
v_alignbit_b32 v32, v129, v128, 16
v_alignbit_b32 v33, v130, v129, 16
v_alignbit_b32 v34, v131, v130, 16
s_mov_b64 s[76:77], exec
s_cmp_eq_u32 s62, 0
s_cselect_b32 s78, 0xffffff, 0
s_mov_b32 s79, 0
s_mov_b64 exec, s[78:79]
s_cbranch_execz CV_NOW4
ds_write_b64 v222, v[128:129] offset:2048
ds_write_b64 v222, v[32:33] offset:4288
v_add_u32 v7, 2048, v223
ds_write2_b32 v7, v129, v130 offset0:0 offset1:1
v_add_u32 v6, 2048, v224
ds_write2_b32 v6, v33, v34 offset0:0 offset1:1
CV_NOW4:
s_mov_b64 exec, s[76:77]
s_waitcnt lgkmcnt(0)
s_barrier
s_cmp_eq_u32 s62, 1
s_waitcnt vmcnt(0)
s_cbranch_scc1 CV_R1
ds_read_b64 v[184:185], v208 offset:2048
ds_read_b64 v[186:187], v208 offset:2056
ds_read_b128 v[196:199], v220 offset:96
ds_read_b64 v[188:189], v208 offset:2080
ds_read_b64 v[190:191], v208 offset:2088
ds_read_b128 v[200:203], v219 offset:0
ds_read_b64 v[192:193], v208 offset:2112
ds_read_b64 v[194:195], v208 offset:2120
ds_read_b128 v[204:207], v219 offset:32
s_waitcnt lgkmcnt(6)
v_mfma_f32_32x32x16_bf16 v[8:23], v[184:187], v[196:199], v[8:23]
ds_read_b64 v[24:25], v208 offset:0
ds_read_b64 v[26:27], v208 offset:8
ds_read_b128 v[44:47], v209 offset:96
s_waitcnt lgkmcnt(6)
v_mfma_f32_32x32x16_bf16 v[8:23], v[188:191], v[200:203], v[8:23]
ds_read_b64 v[28:29], v208 offset:32
ds_read_b64 v[30:31], v208 offset:40
ds_read_b128 v[48:51], v209 offset:144
s_waitcnt lgkmcnt(6)
v_mfma_f32_32x32x16_bf16 v[8:23], v[192:195], v[204:207], v[8:23]
ds_read_b64 v[32:33], v208 offset:64
ds_read_b64 v[34:35], v208 offset:72
ds_read_b128 v[52:55], v209 offset:176
s_waitcnt lgkmcnt(6)
v_mfma_f32_32x32x16_bf16 v[8:23], v[24:27], v[44:47], v[8:23]
ds_read_b64 v[36:37], v208 offset:96
ds_read_b64 v[38:39], v208 offset:104
ds_read_b128 v[56:59], v209 offset:208
s_waitcnt lgkmcnt(6)
v_mfma_f32_32x32x16_bf16 v[8:23], v[28:31], v[48:51], v[8:23]
ds_read_b64 v[40:41], v208 offset:128
ds_read_b64 v[42:43], v208 offset:136
ds_read_b128 v[60:63], v209 offset:240
s_waitcnt lgkmcnt(6)
v_mfma_f32_32x32x16_bf16 v[8:23], v[32:35], v[52:55], v[8:23]
ds_read_b64 v[24:25], v208 offset:160
ds_read_b64 v[26:27], v208 offset:168
ds_read_b128 v[44:47], v209 offset:288
s_waitcnt lgkmcnt(6)
v_mfma_f32_32x32x16_bf16 v[8:23], v[36:39], v[56:59], v[8:23]
ds_read_b64 v[28:29], v208 offset:192
ds_read_b64 v[30:31], v208 offset:200
ds_read_b128 v[48:51], v209 offset:320
s_waitcnt lgkmcnt(6)
v_mfma_f32_32x32x16_bf16 v[8:23], v[40:43], v[60:63], v[8:23]
ds_read_b64 v[32:33], v208 offset:224
ds_read_b64 v[34:35], v208 offset:232
ds_read_b128 v[52:55], v209 offset:352
s_waitcnt lgkmcnt(6)
v_mfma_f32_32x32x16_bf16 v[8:23], v[24:27], v[44:47], v[8:23]
ds_read_b64 v[36:37], v208 offset:256
ds_read_b64 v[38:39], v208 offset:264
ds_read_b128 v[56:59], v209 offset:384
s_waitcnt lgkmcnt(6)
v_mfma_f32_32x32x16_bf16 v[8:23], v[28:31], v[48:51], v[8:23]
ds_read_b64 v[40:41], v208 offset:288
ds_read_b64 v[42:43], v208 offset:296
ds_read_b128 v[60:63], v209 offset:432
s_waitcnt lgkmcnt(6)
v_mfma_f32_32x32x16_bf16 v[8:23], v[32:35], v[52:55], v[8:23]
ds_read_b64 v[24:25], v208 offset:320
ds_read_b64 v[26:27], v208 offset:328
ds_read_b128 v[44:47], v209 offset:464
s_waitcnt lgkmcnt(6)
v_mfma_f32_32x32x16_bf16 v[8:23], v[36:39], v[56:59], v[8:23]
ds_read_b64 v[28:29], v208 offset:352
ds_read_b64 v[30:31], v208 offset:360
ds_read_b128 v[48:51], v209 offset:496
s_waitcnt lgkmcnt(6)
v_mfma_f32_32x32x16_bf16 v[8:23], v[40:43], v[60:63], v[8:23]
ds_read_b64 v[32:33], v208 offset:384
ds_read_b64 v[34:35], v208 offset:392
ds_read_b128 v[52:55], v209 offset:528
s_waitcnt lgkmcnt(6)
v_mfma_f32_32x32x16_bf16 v[8:23], v[24:27], v[44:47], v[8:23]
ds_read_b64 v[36:37], v208 offset:416
ds_read_b64 v[38:39], v208 offset:424
ds_read_b128 v[56:59], v209 offset:576
s_waitcnt lgkmcnt(6)
v_mfma_f32_32x32x16_bf16 v[8:23], v[28:31], v[48:51], v[8:23]
ds_read_b64 v[40:41], v208 offset:448
ds_read_b64 v[42:43], v208 offset:456
ds_read_b128 v[60:63], v209 offset:608
s_waitcnt lgkmcnt(6)
v_mfma_f32_32x32x16_bf16 v[8:23], v[32:35], v[52:55], v[8:23]
ds_read_b64 v[24:25], v208 offset:480
ds_read_b64 v[26:27], v208 offset:488
ds_read_b128 v[44:47], v209 offset:640
s_waitcnt lgkmcnt(6)
v_mfma_f32_32x32x16_bf16 v[8:23], v[36:39], v[56:59], v[8:23]
ds_read_b64 v[28:29], v208 offset:512
ds_read_b64 v[30:31], v208 offset:520
ds_read_b128 v[48:51], v209 offset:672
s_waitcnt lgkmcnt(6)
v_mfma_f32_32x32x16_bf16 v[8:23], v[40:43], v[60:63], v[8:23]
ds_read_b64 v[32:33], v208 offset:544
ds_read_b64 v[34:35], v208 offset:552
ds_read_b128 v[52:55], v209 offset:720
s_waitcnt lgkmcnt(6)
v_mfma_f32_32x32x16_bf16 v[8:23], v[24:27], v[44:47], v[8:23]
ds_read_b64 v[36:37], v208 offset:576
ds_read_b64 v[38:39], v208 offset:584
ds_read_b128 v[56:59], v209 offset:752
s_waitcnt lgkmcnt(6)
v_mfma_f32_32x32x16_bf16 v[8:23], v[28:31], v[48:51], v[8:23]
ds_read_b64 v[40:41], v208 offset:608
ds_read_b64 v[42:43], v208 offset:616
ds_read_b128 v[60:63], v209 offset:784
s_waitcnt lgkmcnt(6)
v_mfma_f32_32x32x16_bf16 v[8:23], v[32:35], v[52:55], v[8:23]
ds_read_b64 v[24:25], v208 offset:640
ds_read_b64 v[26:27], v208 offset:648
ds_read_b128 v[44:47], v209 offset:816
s_waitcnt lgkmcnt(6)
v_mfma_f32_32x32x16_bf16 v[8:23], v[36:39], v[56:59], v[8:23]
ds_read_b64 v[28:29], v208 offset:672
ds_read_b64 v[30:31], v208 offset:680
ds_read_b128 v[48:51], v209 offset:864
s_waitcnt lgkmcnt(6)
v_mfma_f32_32x32x16_bf16 v[8:23], v[40:43], v[60:63], v[8:23]
ds_read_b64 v[32:33], v208 offset:704
ds_read_b64 v[34:35], v208 offset:712
ds_read_b128 v[52:55], v209 offset:896
s_waitcnt lgkmcnt(6)
v_mfma_f32_32x32x16_bf16 v[8:23], v[24:27], v[44:47], v[8:23]
ds_read_b64 v[36:37], v208 offset:736
ds_read_b64 v[38:39], v208 offset:744
ds_read_b128 v[56:59], v209 offset:928
s_waitcnt lgkmcnt(6)
v_mfma_f32_32x32x16_bf16 v[8:23], v[28:31], v[48:51], v[8:23]
ds_read_b64 v[40:41], v208 offset:768
ds_read_b64 v[42:43], v208 offset:776
ds_read_b128 v[60:63], v209 offset:960
s_waitcnt lgkmcnt(6)
v_mfma_f32_32x32x16_bf16 v[8:23], v[32:35], v[52:55], v[8:23]
ds_read_b64 v[24:25], v208 offset:800
ds_read_b64 v[26:27], v208 offset:808
ds_read_b128 v[44:47], v209 offset:1008
s_waitcnt lgkmcnt(6)
v_mfma_f32_32x32x16_bf16 v[8:23], v[36:39], v[56:59], v[8:23]
ds_read_b64 v[28:29], v208 offset:832
ds_read_b128 v[144:147], v217 offset:0
ds_read_b128 v[148:151], v218 offset:0
s_waitcnt lgkmcnt(6)
v_mfma_f32_32x32x16_bf16 v[8:23], v[40:43], v[60:63], v[8:23]
ds_read_b64 v[30:31], v208 offset:840
ds_read_b128 v[152:155], v217 offset:576
ds_read_b128 v[156:159], v218 offset:576
s_waitcnt lgkmcnt(6)
v_mfma_f32_32x32x16_bf16 v[8:23], v[24:27], v[44:47], v[8:23]
ds_read_b128 v[48:51], v209 offset:1040
ds_read_b128 v[168:171], v210 offset:0
s_waitcnt lgkmcnt(6)
v_mfma_f32_16x16x32_bf16 v[80:83], v[144:147], v[72:75], 0
ds_read_b64 v[32:33], v208 offset:864
s_waitcnt lgkmcnt(6)
v_mfma_f32_16x16x32_bf16 v[84:87], v[148:151], v[76:79], 0
ds_read_b64 v[34:35], v208 offset:872
ds_read_b128 v[52:55], v209 offset:1072
s_nop 1
v_cvt_pk_bf16_f32 v128, v80, v81
v_cvt_pk_bf16_f32 v129, v82, v83
s_waitcnt lgkmcnt(6)
v_mfma_f32_16x16x32_bf16 v[88:91], v[152:155], v[72:75], 0
ds_read_b64 v[36:37], v208 offset:896
v_cvt_pk_bf16_f32 v130, v84, v85
s_waitcnt lgkmcnt(6)
v_mfma_f32_16x16x32_bf16 v[92:95], v[156:159], v[76:79], 0
ds_read_b64 v[38:39], v208 offset:904
v_cvt_pk_bf16_f32 v131, v86, v87
ds_read_b64 v[116:117], v216 offset:64
s_waitcnt lgkmcnt(7)
v_mfma_f32_32x32x16_bf16 v[8:23], v[28:31], v[48:51], v[8:23]
s_waitcnt lgkmcnt(6)
v_cvt_pk_bf16_f32 v132, v88, v89
ds_read_b128 v[56:59], v209 offset:1104
v_cvt_pk_bf16_f32 v133, v90, v91
v_cvt_pk_bf16_f32 v134, v92, v93
v_cvt_pk_bf16_f32 v135, v94, v95
ds_read_b64 v[40:41], v208 offset:928
v_mfma_f32_16x16x32_bf16 v[80:83], v[168:171], v[64:67], 0
ds_read_b64 v[118:119], v216 offset:224
v_mfma_f32_16x16x32_bf16 v[84:87], v[168:171], v[68:71], 0
ds_read_b128 v[172:175], v210 offset:288
s_waitcnt lgkmcnt(7)
v_mfma_f32_32x32x16_bf16 v[8:23], v[32:35], v[52:55], v[8:23]
ds_read_b64 v[112:113], v216 offset:96
ds_read_b64 v[114:115], v216 offset:256
ds_read_b128 v[176:179], v210 offset:576
s_waitcnt lgkmcnt(6)
v_mfma_f32_32x32x16_bf16 v[8:23], v[36:39], v[56:59], v[8:23]
ds_read_b64 v[42:43], v208 offset:936
ds_read_b128 v[180:183], v210 offset:864
s_waitcnt lgkmcnt(6)
v_mfma_f32_16x16x32_bf16 v[108:111], v[128:131], v[116:119], 0
ds_read_b128 v[60:63], v209 offset:1152
s_waitcnt lgkmcnt(6)
v_mfma_f32_16x16x32_bf16 v[88:91], v[172:175], v[64:67], 0
ds_read_b64 v[24:25], v208 offset:960
v_mfma_f32_16x16x32_bf16 v[92:95], v[172:175], v[68:71], 0
ds_read_b64 v[26:27], v208 offset:968
s_waitcnt lgkmcnt(6)
v_mfma_f32_16x16x32_bf16 v[104:107], v[128:131], v[112:115], 0
ds_read_b128 v[44:47], v209 offset:1184
v_cvt_pk_bf16_f32 v116, v88, v89
v_mfma_f32_16x16x32_bf16 v[108:111], v[132:135], v[112:115], v[108:111]
ds_read_b64 v[28:29], v208 offset:992
v_cvt_pk_bf16_f32 v112, v80, v81
v_cvt_pk_bf16_f32 v113, v82, v83
s_waitcnt lgkmcnt(7)
v_mfma_f32_16x16x32_bf16 v[80:83], v[176:179], v[64:67], 0
ds_read_b64 v[30:31], v208 offset:1000
v_cvt_pk_bf16_f32 v114, v84, v85
ds_read_b128 v[48:51], v209 offset:1216
v_cvt_pk_bf16_f32 v115, v86, v87
v_mfma_f32_16x16x32_bf16 v[84:87], v[176:179], v[68:71], 0
ds_read_b64 v[32:33], v208 offset:1024
v_cvt_pk_bf16_f32 v117, v90, v91
s_waitcnt lgkmcnt(7)
v_mfma_f32_32x32x16_bf16 v[8:23], v[40:43], v[60:63], v[8:23]
ds_read_b64 v[34:35], v208 offset:1032
v_cvt_pk_bf16_f32 v118, v92, v93
v_cvt_pk_bf16_f32 v119, v94, v95
v_cvt_pk_bf16_f32 v120, v80, v81
ds_read_b128 v[52:55], v209 offset:1248
v_cvt_pk_bf16_f32 v121, v82, v83
v_mfma_f32_16x16x32_bf16 v[88:91], v[180:183], v[64:67], 0
ds_read_b64 v[36:37], v208 offset:1056
v_cvt_pk_bf16_f32 v122, v84, v85
s_waitcnt lgkmcnt(7)
v_mfma_f32_32x32x16_bf16 v[8:23], v[24:27], v[44:47], v[8:23]
ds_read_b64 v[38:39], v208 offset:1064
v_cvt_pk_bf16_f32 v123, v86, v87
ds_read_b128 v[168:171], v210 offset:1152
s_nop 0
v_cvt_pk_bf16_f32 v124, v88, v89
v_cvt_pk_bf16_f32 v125, v90, v91
v_mfma_f32_16x16x32_bf16 v[92:95], v[180:183], v[68:71], 0
ds_read_b128 v[56:59], v209 offset:1296
s_waitcnt lgkmcnt(7)
v_mfma_f32_32x32x16_bf16 v[8:23], v[28:31], v[48:51], v[8:23]
ds_read_b64 v[40:41], v208 offset:1088
ds_read_b128 v[172:175], v210 offset:1440
s_nop 1
v_cvt_pk_bf16_f32 v126, v92, v93
v_cvt_pk_bf16_f32 v127, v94, v95
ds_read_b64 v[144:145], v211 offset:0
s_waitcnt lgkmcnt(7)
v_mfma_f32_32x32x16_bf16 v[8:23], v[32:35], v[52:55], v[8:23]
ds_read_b64 v[146:147], v211 offset:256
ds_read_b128 v[176:179], v210 offset:1728
s_waitcnt lgkmcnt(6)
v_mfma_f32_16x16x32_bf16 v[80:83], v[168:171], v[64:67], 0
ds_read_b64 v[42:43], v208 offset:1096
v_mfma_f32_16x16x32_bf16 v[84:87], v[168:171], v[68:71], 0
ds_read_b128 v[60:63], v209 offset:1328
s_waitcnt lgkmcnt(7)
v_mfma_f32_32x32x16_bf16 v[8:23], v[36:39], v[56:59], v[8:23]
ds_read_b64 v[148:149], v211 offset:32
v_cvt_pk_bf16_f32 v128, v80, v81
v_cvt_pk_bf16_f32 v129, v82, v83
ds_read_b64 v[150:151], v211 offset:288
v_cvt_pk_bf16_f32 v130, v84, v85
v_cvt_pk_bf16_f32 v131, v86, v87
s_waitcnt lgkmcnt(7)
v_mfma_f32_16x16x32_bf16 v[88:91], v[172:175], v[64:67], 0
ds_read_b128 v[180:183], v210 offset:2016
v_mfma_f32_16x16x32_bf16 v[92:95], v[172:175], v[68:71], 0
ds_read_b64 v[152:153], v211 offset:64
s_waitcnt lgkmcnt(7)
v_mfma_f32_16x16x32_bf16 v[104:107], v[112:115], v[144:147], v[104:107]
ds_read_b64 v[154:155], v211 offset:320
v_cvt_pk_bf16_f32 v132, v88, v89
v_mfma_f32_16x16x32_bf16 v[108:111], v[120:123], v[144:147], v[108:111]
ds_read_b64 v[156:157], v211 offset:96
v_cvt_pk_bf16_f32 v133, v90, v91
s_waitcnt lgkmcnt(8)
v_mfma_f32_16x16x32_bf16 v[80:83], v[176:179], v[64:67], 0
ds_read_b64 v[158:159], v211 offset:352
v_cvt_pk_bf16_f32 v134, v92, v93
s_waitcnt lgkmcnt(7)
v_mfma_f32_32x32x16_bf16 v[8:23], v[40:43], v[60:63], v[8:23]
s_waitcnt lgkmcnt(5)
ds_read_b64 v[160:161], v211 offset:128
v_cvt_pk_bf16_f32 v135, v94, v95
ds_read_b64 v[162:163], v211 offset:384
s_nop 0
v_cvt_pk_bf16_f32 v136, v80, v81
v_cvt_pk_bf16_f32 v137, v82, v83
v_mfma_f32_16x16x32_bf16 v[84:87], v[176:179], v[68:71], 0
ds_read_b64 v[164:165], v211 offset:160
v_mfma_f32_16x16x32_bf16 v[104:107], v[116:119], v[148:151], v[104:107]
ds_read_b64 v[166:167], v211 offset:416
v_mfma_f32_16x16x32_bf16 v[108:111], v[124:127], v[148:151], v[108:111]
v_cvt_pk_bf16_f32 v138, v84, v85
v_cvt_pk_bf16_f32 v139, v86, v87
s_waitcnt lgkmcnt(8)
v_mfma_f32_16x16x32_bf16 v[88:91], v[180:183], v[64:67], 0
v_mfma_f32_16x16x32_bf16 v[92:95], v[180:183], v[68:71], 0
s_waitcnt lgkmcnt(6)
v_mfma_f32_16x16x32_bf16 v[100:103], v[112:115], v[152:155], 0
v_cvt_pk_bf16_f32 v140, v88, v89
v_cvt_pk_bf16_f32 v141, v90, v91
v_mfma_f32_16x16x32_bf16 v[104:107], v[120:123], v[152:155], v[104:107]
v_cvt_pk_bf16_f32 v142, v92, v93
v_cvt_pk_bf16_f32 v143, v94, v95
v_mfma_f32_16x16x32_bf16 v[108:111], v[128:131], v[152:155], v[108:111]
s_waitcnt lgkmcnt(4)
v_mfma_f32_16x16x32_bf16 v[100:103], v[116:119], v[156:159], v[100:103]
v_mfma_f32_16x16x32_bf16 v[104:107], v[124:127], v[156:159], v[104:107]
v_mfma_f32_16x16x32_bf16 v[108:111], v[132:135], v[156:159], v[108:111]
s_waitcnt lgkmcnt(2)
v_mfma_f32_16x16x32_bf16 v[96:99], v[112:115], v[160:163], 0
v_mfma_f32_16x16x32_bf16 v[100:103], v[120:123], v[160:163], v[100:103]
v_mfma_f32_16x16x32_bf16 v[104:107], v[128:131], v[160:163], v[104:107]
v_mfma_f32_16x16x32_bf16 v[108:111], v[136:139], v[160:163], v[108:111]
s_waitcnt lgkmcnt(0)
v_mfma_f32_16x16x32_bf16 v[96:99], v[116:119], v[164:167], v[96:99]
v_mfma_f32_16x16x32_bf16 v[100:103], v[124:127], v[164:167], v[100:103]
v_mfma_f32_16x16x32_bf16 v[104:107], v[132:135], v[164:167], v[104:107]
ds_write_b128 v212, v[96:99] offset:0
v_mfma_f32_16x16x32_bf16 v[108:111], v[140:143], v[164:167], v[108:111]
ds_write_b128 v212, v[100:103] offset:1088
s_nop 2
ds_write_b128 v212, v[104:107] offset:2176
s_nop 2
ds_write_b128 v212, v[108:111] offset:3264
s_waitcnt lgkmcnt(0)
s_branch CV_JOIN
CV_R1:
ds_read_b64 v[184:185], v208 offset:2048
ds_read_b64 v[186:187], v208 offset:2056
ds_read_b128 v[196:199], v219 offset:32
ds_read_b64 v[188:189], v208 offset:2080
ds_read_b64 v[190:191], v208 offset:2088
ds_read_b128 v[200:203], v219 offset:64
ds_read_b64 v[192:193], v208 offset:2112
ds_read_b64 v[194:195], v208 offset:2120
ds_read_b128 v[204:207], v219 offset:96
s_waitcnt lgkmcnt(6)
v_mfma_f32_32x32x16_bf16 v[8:23], v[184:187], v[196:199], v[8:23]
ds_read_b64 v[24:25], v208 offset:0
ds_read_b64 v[26:27], v208 offset:8
ds_read_b128 v[44:47], v209 offset:176
s_waitcnt lgkmcnt(6)
v_mfma_f32_32x32x16_bf16 v[8:23], v[188:191], v[200:203], v[8:23]
ds_read_b64 v[28:29], v208 offset:32
ds_read_b64 v[30:31], v208 offset:40
ds_read_b128 v[48:51], v209 offset:208
s_waitcnt lgkmcnt(6)
v_mfma_f32_32x32x16_bf16 v[8:23], v[192:195], v[204:207], v[8:23]
ds_read_b64 v[32:33], v208 offset:64
ds_read_b64 v[34:35], v208 offset:72
ds_read_b128 v[52:55], v209 offset:240
s_waitcnt lgkmcnt(6)
v_mfma_f32_32x32x16_bf16 v[8:23], v[24:27], v[44:47], v[8:23]
ds_read_b64 v[36:37], v208 offset:96
ds_read_b64 v[38:39], v208 offset:104
ds_read_b128 v[56:59], v209 offset:288
s_waitcnt lgkmcnt(6)
v_mfma_f32_32x32x16_bf16 v[8:23], v[28:31], v[48:51], v[8:23]
ds_read_b64 v[40:41], v208 offset:128
ds_read_b64 v[42:43], v208 offset:136
ds_read_b128 v[60:63], v209 offset:320
s_waitcnt lgkmcnt(6)
v_mfma_f32_32x32x16_bf16 v[8:23], v[32:35], v[52:55], v[8:23]
ds_read_b64 v[24:25], v208 offset:160
ds_read_b64 v[26:27], v208 offset:168
ds_read_b128 v[44:47], v209 offset:352
s_waitcnt lgkmcnt(6)
v_mfma_f32_32x32x16_bf16 v[8:23], v[36:39], v[56:59], v[8:23]
ds_read_b64 v[28:29], v208 offset:192
ds_read_b64 v[30:31], v208 offset:200
ds_read_b128 v[48:51], v209 offset:384
s_waitcnt lgkmcnt(6)
v_mfma_f32_32x32x16_bf16 v[8:23], v[40:43], v[60:63], v[8:23]
ds_read_b64 v[32:33], v208 offset:224
ds_read_b64 v[34:35], v208 offset:232
ds_read_b128 v[52:55], v209 offset:432
s_waitcnt lgkmcnt(6)
v_mfma_f32_32x32x16_bf16 v[8:23], v[24:27], v[44:47], v[8:23]
ds_read_b64 v[36:37], v208 offset:256
ds_read_b64 v[38:39], v208 offset:264
ds_read_b128 v[56:59], v209 offset:464
s_waitcnt lgkmcnt(6)
v_mfma_f32_32x32x16_bf16 v[8:23], v[28:31], v[48:51], v[8:23]
ds_read_b64 v[40:41], v208 offset:288
ds_read_b64 v[42:43], v208 offset:296
ds_read_b128 v[60:63], v209 offset:496
s_waitcnt lgkmcnt(6)
v_mfma_f32_32x32x16_bf16 v[8:23], v[32:35], v[52:55], v[8:23]
ds_read_b64 v[24:25], v208 offset:320
ds_read_b64 v[26:27], v208 offset:328
ds_read_b128 v[44:47], v209 offset:528
s_waitcnt lgkmcnt(6)
v_mfma_f32_32x32x16_bf16 v[8:23], v[36:39], v[56:59], v[8:23]
ds_read_b64 v[28:29], v208 offset:352
ds_read_b64 v[30:31], v208 offset:360
ds_read_b128 v[48:51], v209 offset:576
s_waitcnt lgkmcnt(6)
v_mfma_f32_32x32x16_bf16 v[8:23], v[40:43], v[60:63], v[8:23]
ds_read_b64 v[32:33], v208 offset:384
ds_read_b64 v[34:35], v208 offset:392
ds_read_b128 v[52:55], v209 offset:608
s_waitcnt lgkmcnt(6)
v_mfma_f32_32x32x16_bf16 v[8:23], v[24:27], v[44:47], v[8:23]
ds_read_b64 v[36:37], v208 offset:416
ds_read_b64 v[38:39], v208 offset:424
ds_read_b128 v[56:59], v209 offset:640
s_waitcnt lgkmcnt(6)
v_mfma_f32_32x32x16_bf16 v[8:23], v[28:31], v[48:51], v[8:23]
ds_read_b64 v[40:41], v208 offset:448
ds_read_b64 v[42:43], v208 offset:456
ds_read_b128 v[60:63], v209 offset:672
s_waitcnt lgkmcnt(6)
v_mfma_f32_32x32x16_bf16 v[8:23], v[32:35], v[52:55], v[8:23]
ds_read_b64 v[24:25], v208 offset:480
ds_read_b64 v[26:27], v208 offset:488
ds_read_b128 v[44:47], v209 offset:720
s_waitcnt lgkmcnt(6)
v_mfma_f32_32x32x16_bf16 v[8:23], v[36:39], v[56:59], v[8:23]
ds_read_b64 v[28:29], v208 offset:512
ds_read_b64 v[30:31], v208 offset:520
ds_read_b128 v[48:51], v209 offset:752
s_waitcnt lgkmcnt(6)
v_mfma_f32_32x32x16_bf16 v[8:23], v[40:43], v[60:63], v[8:23]
ds_read_b64 v[32:33], v208 offset:544
ds_read_b64 v[34:35], v208 offset:552
ds_read_b128 v[52:55], v209 offset:784
s_waitcnt lgkmcnt(6)
v_mfma_f32_32x32x16_bf16 v[8:23], v[24:27], v[44:47], v[8:23]
ds_read_b64 v[36:37], v208 offset:576
ds_read_b64 v[38:39], v208 offset:584
ds_read_b128 v[56:59], v209 offset:816
s_waitcnt lgkmcnt(6)
v_mfma_f32_32x32x16_bf16 v[8:23], v[28:31], v[48:51], v[8:23]
ds_read_b64 v[40:41], v208 offset:608
ds_read_b64 v[42:43], v208 offset:616
ds_read_b128 v[60:63], v209 offset:864
s_waitcnt lgkmcnt(6)
v_mfma_f32_32x32x16_bf16 v[8:23], v[32:35], v[52:55], v[8:23]
ds_read_b64 v[24:25], v208 offset:640
ds_read_b64 v[26:27], v208 offset:648
ds_read_b128 v[44:47], v209 offset:896
s_waitcnt lgkmcnt(6)
v_mfma_f32_32x32x16_bf16 v[8:23], v[36:39], v[56:59], v[8:23]
ds_read_b64 v[28:29], v208 offset:672
ds_read_b64 v[30:31], v208 offset:680
ds_read_b128 v[48:51], v209 offset:928
s_waitcnt lgkmcnt(6)
v_mfma_f32_32x32x16_bf16 v[8:23], v[40:43], v[60:63], v[8:23]
ds_read_b64 v[32:33], v208 offset:704
ds_read_b128 v[152:155], v217 offset:576
ds_read_b64 v[34:35], v208 offset:712
s_waitcnt lgkmcnt(6)
v_mfma_f32_32x32x16_bf16 v[8:23], v[24:27], v[44:47], v[8:23]
ds_read_b128 v[52:55], v209 offset:960
ds_read_b128 v[156:159], v218 offset:576
ds_read_b128 v[168:171], v217 offset:1728
s_waitcnt lgkmcnt(6)
v_mfma_f32_32x32x16_bf16 v[8:23], v[28:31], v[48:51], v[8:23]
ds_read_b64 v[36:37], v208 offset:736
ds_read_b64 v[38:39], v208 offset:744
s_waitcnt lgkmcnt(6)
v_mfma_f32_16x16x32_bf16 v[88:91], v[152:155], v[72:75], 0
ds_read_b128 v[56:59], v209 offset:1008
ds_read_b128 v[172:175], v218 offset:1728
ds_read_b128 v[144:147], v217 offset:0
s_waitcnt lgkmcnt(7)
v_mfma_f32_32x32x16_bf16 v[8:23], v[32:35], v[52:55], v[8:23]
s_nop 2
v_cvt_pk_bf16_f32 v132, v88, v89
ds_read_b64 v[40:41], v208 offset:768
v_cvt_pk_bf16_f32 v133, v90, v91
ds_read_b128 v[148:151], v218 offset:0
s_waitcnt lgkmcnt(8)
v_mfma_f32_16x16x32_bf16 v[92:95], v[156:159], v[76:79], 0
ds_read_b64 v[42:43], v208 offset:776
s_waitcnt lgkmcnt(8)
v_mfma_f32_16x16x32_bf16 v[88:91], v[168:171], v[72:75], 0
ds_read_b128 v[60:63], v209 offset:1040
s_nop 2
v_cvt_pk_bf16_f32 v134, v92, v93
ds_read_b64 v[24:25], v208 offset:800
s_waitcnt lgkmcnt(7)
v_mfma_f32_32x32x16_bf16 v[8:23], v[36:39], v[56:59], v[8:23]
s_waitcnt lgkmcnt(6)
v_cvt_pk_bf16_f32 v135, v94, v95
ds_read_b64 v[26:27], v208 offset:808
v_cvt_pk_bf16_f32 v140, v88, v89
v_cvt_pk_bf16_f32 v141, v90, v91
ds_read_b128 v[44:47], v209 offset:1072
v_mfma_f32_16x16x32_bf16 v[92:95], v[172:175], v[76:79], 0
ds_read_b128 v[160:163], v217 offset:1152
s_waitcnt lgkmcnt(8)
v_mfma_f32_16x16x32_bf16 v[80:83], v[144:147], v[72:75], 0
ds_read_b128 v[164:167], v218 offset:1152
s_waitcnt lgkmcnt(7)
v_mfma_f32_16x16x32_bf16 v[84:87], v[148:151], v[76:79], 0
v_cvt_pk_bf16_f32 v142, v92, v93
ds_read_b64 v[28:29], v208 offset:832
v_cvt_pk_bf16_f32 v143, v94, v95
s_nop 0
v_cvt_pk_bf16_f32 v128, v80, v81
s_waitcnt lgkmcnt(6)
v_mfma_f32_32x32x16_bf16 v[8:23], v[40:43], v[60:63], v[8:23]
ds_read_b64 v[30:31], v208 offset:840
v_cvt_pk_bf16_f32 v129, v82, v83
ds_read_b128 v[48:51], v209 offset:1104
v_cvt_pk_bf16_f32 v130, v84, v85
v_cvt_pk_bf16_f32 v131, v86, v87
ds_read_b128 v[168:171], v210 offset:1152
s_waitcnt lgkmcnt(6)
v_mfma_f32_32x32x16_bf16 v[8:23], v[24:27], v[44:47], v[8:23]
ds_read_b64 v[32:33], v208 offset:864
ds_read_b64 v[34:35], v208 offset:872
s_waitcnt lgkmcnt(7)
v_mfma_f32_16x16x32_bf16 v[80:83], v[160:163], v[72:75], 0
ds_read_b128 v[52:55], v209 offset:1152
s_waitcnt lgkmcnt(7)
v_mfma_f32_16x16x32_bf16 v[84:87], v[164:167], v[76:79], 0
ds_read_b64 v[36:37], v208 offset:896
ds_read_b128 v[172:175], v210 offset:1440
s_nop 1
v_cvt_pk_bf16_f32 v136, v80, v81
v_cvt_pk_bf16_f32 v137, v82, v83
s_waitcnt lgkmcnt(6)
v_mfma_f32_32x32x16_bf16 v[8:23], v[28:31], v[48:51], v[8:23]
ds_read_b64 v[38:39], v208 offset:904
v_cvt_pk_bf16_f32 v138, v84, v85
v_cvt_pk_bf16_f32 v139, v86, v87
ds_read_b128 v[56:59], v209 offset:1184
s_waitcnt lgkmcnt(7)
v_mfma_f32_16x16x32_bf16 v[80:83], v[168:171], v[64:67], 0
ds_read_b64 v[40:41], v208 offset:928
v_mfma_f32_16x16x32_bf16 v[84:87], v[168:171], v[68:71], 0
ds_read_b64 v[42:43], v208 offset:936
ds_read_b64 v[120:121], v216 offset:32
s_waitcnt lgkmcnt(7)
v_mfma_f32_32x32x16_bf16 v[8:23], v[32:35], v[52:55], v[8:23]
ds_read_b64 v[122:123], v216 offset:192
ds_read_b64 v[124:125], v216 offset:0
s_waitcnt lgkmcnt(7)
v_mfma_f32_16x16x32_bf16 v[88:91], v[172:175], v[64:67], 0
ds_read_b64 v[126:127], v216 offset:160
v_mfma_f32_16x16x32_bf16 v[92:95], v[172:175], v[68:71], 0
ds_read_b128 v[176:179], v210 offset:1728
s_waitcnt lgkmcnt(7)
v_mfma_f32_32x32x16_bf16 v[8:23], v[36:39], v[56:59], v[8:23]
ds_read_b64 v[116:117], v216 offset:64
ds_read_b64 v[118:119], v216 offset:224
ds_read_b128 v[180:183], v210 offset:2016
s_waitcnt lgkmcnt(6)
v_mfma_f32_16x16x32_bf16 v[96:99], v[128:131], v[120:123], 0
ds_read_b128 v[60:63], v209 offset:1216
ds_read_b64 v[112:113], v216 offset:96
s_waitcnt lgkmcnt(6)
v_mfma_f32_16x16x32_bf16 v[100:103], v[128:131], v[124:127], 0
ds_read_b64 v[24:25], v208 offset:960
v_cvt_pk_bf16_f32 v128, v80, v81
v_mfma_f32_16x16x32_bf16 v[100:103], v[132:135], v[120:123], v[100:103]
ds_read_b64 v[26:27], v208 offset:968
v_cvt_pk_bf16_f32 v129, v82, v83
s_waitcnt lgkmcnt(7)
v_mfma_f32_16x16x32_bf16 v[80:83], v[176:179], v[64:67], 0
ds_read_b128 v[44:47], v209 offset:1248
v_cvt_pk_bf16_f32 v130, v84, v85
s_waitcnt lgkmcnt(6)
v_mfma_f32_16x16x32_bf16 v[96:99], v[132:135], v[116:119], v[96:99]
ds_read_b64 v[28:29], v208 offset:992
v_cvt_pk_bf16_f32 v131, v86, v87
v_mfma_f32_16x16x32_bf16 v[84:87], v[176:179], v[68:71], 0
ds_read_b64 v[30:31], v208 offset:1000
v_cvt_pk_bf16_f32 v132, v88, v89
v_mfma_f32_16x16x32_bf16 v[100:103], v[136:139], v[116:119], v[100:103]
ds_read_b128 v[48:51], v209 offset:1296
v_cvt_pk_bf16_f32 v133, v90, v91
s_waitcnt lgkmcnt(7)
v_mfma_f32_32x32x16_bf16 v[8:23], v[40:43], v[60:63], v[8:23]
ds_read_b64 v[32:33], v208 offset:1024
v_cvt_pk_bf16_f32 v134, v92, v93
v_cvt_pk_bf16_f32 v135, v94, v95
ds_read_b64 v[34:35], v208 offset:1032
v_mfma_f32_16x16x32_bf16 v[88:91], v[180:183], v[64:67], 0
ds_read_b128 v[52:55], v209 offset:1328
v_mfma_f32_16x16x32_bf16 v[92:95], v[180:183], v[68:71], 0
ds_read_b64 v[36:37], v208 offset:1056
s_waitcnt lgkmcnt(7)
v_mfma_f32_32x32x16_bf16 v[8:23], v[24:27], v[44:47], v[8:23]
ds_read_b64 v[38:39], v208 offset:1064
ds_read_b64 v[114:115], v216 offset:256
ds_read_b128 v[168:171], v210 offset:2304
s_waitcnt lgkmcnt(7)
v_mfma_f32_32x32x16_bf16 v[8:23], v[28:31], v[48:51], v[8:23]
ds_read_b128 v[172:175], v210 offset:2592
ds_read_b64 v[144:145], v211 offset:0
ds_read_b64 v[146:147], v211 offset:256
s_waitcnt lgkmcnt(7)
v_mfma_f32_32x32x16_bf16 v[8:23], v[32:35], v[52:55], v[8:23]
ds_read_b128 v[176:179], v210 offset:2880
ds_read_b64 v[148:149], v211 offset:32
s_waitcnt lgkmcnt(6)
v_mfma_f32_16x16x32_bf16 v[96:99], v[136:139], v[112:115], v[96:99]
ds_read_b128 v[56:59], v209 offset:1360
v_cvt_pk_bf16_f32 v136, v80, v81
v_mfma_f32_16x16x32_bf16 v[100:103], v[140:143], v[112:115], v[100:103]
ds_read_b64 v[40:41], v208 offset:1088
v_cvt_pk_bf16_f32 v137, v82, v83
s_waitcnt lgkmcnt(7)
v_mfma_f32_16x16x32_bf16 v[80:83], v[168:171], v[64:67], 0
ds_read_b64 v[42:43], v208 offset:1096
v_cvt_pk_bf16_f32 v138, v84, v85
v_cvt_pk_bf16_f32 v139, v86, v87
v_mfma_f32_16x16x32_bf16 v[84:87], v[168:171], v[68:71], 0
ds_read_b128 v[60:63], v209 offset:1392
v_cvt_pk_bf16_f32 v140, v88, v89
s_waitcnt lgkmcnt(6)
v_mfma_f32_16x16x32_bf16 v[96:99], v[128:131], v[144:147], v[96:99]
ds_read_b64 v[150:151], v211 offset:288
v_cvt_pk_bf16_f32 v141, v90, v91
v_mfma_f32_16x16x32_bf16 v[88:91], v[172:175], v[64:67], 0
ds_read_b128 v[180:183], v210 offset:3168
v_cvt_pk_bf16_f32 v142, v92, v93
v_mfma_f32_16x16x32_bf16 v[100:103], v[136:139], v[144:147], v[100:103]
ds_read_b64 v[152:153], v211 offset:64
v_cvt_pk_bf16_f32 v143, v94, v95
v_mfma_f32_16x16x32_bf16 v[92:95], v[172:175], v[68:71], 0
ds_read_b64 v[154:155], v211 offset:320
v_cvt_pk_bf16_f32 v112, v80, v81
s_waitcnt lgkmcnt(7)
v_mfma_f32_32x32x16_bf16 v[8:23], v[36:39], v[56:59], v[8:23]
ds_read_b64 v[156:157], v211 offset:96
v_cvt_pk_bf16_f32 v113, v82, v83
ds_read_b64 v[158:159], v211 offset:352
v_cvt_pk_bf16_f32 v114, v84, v85
v_cvt_pk_bf16_f32 v115, v86, v87
v_cvt_pk_bf16_f32 v116, v88, v89
v_mfma_f32_16x16x32_bf16 v[80:83], v[176:179], v[64:67], 0
ds_read_b64 v[160:161], v211 offset:128
v_cvt_pk_bf16_f32 v117, v90, v91
s_waitcnt lgkmcnt(7)
v_mfma_f32_32x32x16_bf16 v[8:23], v[40:43], v[60:63], v[8:23]
s_waitcnt lgkmcnt(6)
ds_read_b64 v[162:163], v211 offset:384
v_cvt_pk_bf16_f32 v118, v92, v93
ds_read_b64 v[164:165], v211 offset:160
v_cvt_pk_bf16_f32 v119, v94, v95
v_cvt_pk_bf16_f32 v120, v80, v81
v_cvt_pk_bf16_f32 v121, v82, v83
v_mfma_f32_16x16x32_bf16 v[84:87], v[176:179], v[68:71], 0
ds_read_b64 v[166:167], v211 offset:416
v_mfma_f32_16x16x32_bf16 v[96:99], v[132:135], v[148:151], v[96:99]
v_mfma_f32_16x16x32_bf16 v[100:103], v[140:143], v[148:151], v[100:103]
v_cvt_pk_bf16_f32 v122, v84, v85
v_cvt_pk_bf16_f32 v123, v86, v87
s_waitcnt lgkmcnt(8)
v_mfma_f32_16x16x32_bf16 v[88:91], v[180:183], v[64:67], 0
v_mfma_f32_16x16x32_bf16 v[92:95], v[180:183], v[68:71], 0
s_waitcnt lgkmcnt(6)
v_mfma_f32_16x16x32_bf16 v[96:99], v[136:139], v[152:155], v[96:99]
v_cvt_pk_bf16_f32 v124, v88, v89
v_cvt_pk_bf16_f32 v125, v90, v91
v_mfma_f32_16x16x32_bf16 v[100:103], v[112:115], v[152:155], v[100:103]
v_cvt_pk_bf16_f32 v126, v92, v93
v_cvt_pk_bf16_f32 v127, v94, v95
s_waitcnt lgkmcnt(4)
v_mfma_f32_16x16x32_bf16 v[96:99], v[140:143], v[156:159], v[96:99]
v_mfma_f32_16x16x32_bf16 v[100:103], v[116:119], v[156:159], v[100:103]
s_waitcnt lgkmcnt(2)
v_mfma_f32_16x16x32_bf16 v[96:99], v[112:115], v[160:163], v[96:99]
v_mfma_f32_16x16x32_bf16 v[100:103], v[120:123], v[160:163], v[100:103]
s_waitcnt lgkmcnt(0)
v_mfma_f32_16x16x32_bf16 v[96:99], v[116:119], v[164:167], v[96:99]
v_mfma_f32_16x16x32_bf16 v[100:103], v[124:127], v[164:167], v[100:103]
s_nop 3
ds_write_b128 v212, v[96:99] offset:4352
s_nop 2
ds_write_b128 v212, v[100:103] offset:5440
s_waitcnt lgkmcnt(0)
CV_JOIN:
s_barrier
s_mov_b64 s[76:77], exec
s_mov_b32 s78, 0xffffff00
s_mov_b32 s79, 0xffffff00
s_mov_b64 exec, s[78:79]
ds_read_b128 v[24:27], v213 offset:0
ds_read_b128 v[28:31], v213 offset:32
ds_read_b128 v[32:35], v213 offset:64
ds_read_b128 v[36:39], v213 offset:96
s_waitcnt lgkmcnt(3)
v_pk_add_f32 v[8:9], v[8:9], v[24:25]
v_pk_add_f32 v[10:11], v[10:11], v[26:27]
s_waitcnt lgkmcnt(2)
v_pk_add_f32 v[12:13], v[12:13], v[28:29]
v_pk_add_f32 v[14:15], v[14:15], v[30:31]
s_waitcnt lgkmcnt(1)
v_pk_add_f32 v[16:17], v[16:17], v[32:33]
v_pk_add_f32 v[18:19], v[18:19], v[34:35]
s_waitcnt lgkmcnt(0)
v_pk_add_f32 v[20:21], v[20:21], v[36:37]
v_pk_add_f32 v[22:23], v[22:23], v[38:39]
s_mov_b64 exec, s[76:77]
v_cvt_pk_bf16_f32 v44, v8, v9
v_cvt_pk_bf16_f32 v45, v10, v11
ds_write_b64 v214, v[44:45] offset:0
v_cvt_pk_bf16_f32 v46, v12, v13
v_cvt_pk_bf16_f32 v47, v14, v15
ds_write_b64 v214, v[46:47] offset:16
v_cvt_pk_bf16_f32 v48, v16, v17
v_cvt_pk_bf16_f32 v49, v18, v19
ds_write_b64 v214, v[48:49] offset:32
v_cvt_pk_bf16_f32 v50, v20, v21
v_cvt_pk_bf16_f32 v51, v22, v23
ds_write_b64 v214, v[50:51] offset:48
s_waitcnt lgkmcnt(0)
s_barrier
ds_read_b128 v[56:59], v215 offset:0
ds_read_b128 v[60:63], v215 offset:1152
s_waitcnt lgkmcnt(1)
buffer_store_dwordx4 v[56:59], v5, s[64:67], s72 offen offset:0 sc1
s_waitcnt lgkmcnt(0)
buffer_store_dwordx4 v[60:63], v5, s[64:67], s72 offen offset:1024 sc1
s_endpgm
.globl k3_kernel
.p2align 8
.type k3_kernel,@function
k3_kernel:
s_load_dwordx16 s[16:31], s[0:1], 0
s_load_dwordx8 s[32:39], s[0:1], 64
s_load_dwordx2 s[40:41], s[0:1], 96
s_waitcnt lgkmcnt(0)
s_cmp_lt_u32 s2, 256
s_cbranch_scc1 k3_kernel_P3
s_cmp_lt_u32 s2, 416
s_cbranch_scc1 k3_kernel_YT
s_endpgm
k3_kernel_P3:
s_sub_u32 s3, s2, 0
s_mov_b32 s44, s40
s_mov_b32 s45, s41
s_and_b32 s45, s45, 0xffff
s_mov_b32 s46, 0x2a0000
s_mov_b32 s47, 0x20000
s_mov_b32 s48, s36
s_mov_b32 s49, s37
s_and_b32 s49, s49, 0xffff
s_mov_b32 s50, 0x500000
s_mov_b32 s51, 0x20000
v_and_b32 v1, 63, v0
v_and_b32 v2, 15, v1
v_lshrrev_b32 v3, 4, v1
v_lshrrev_b32 v4, 6, v0
s_nop 0
v_readfirstlane_b32 s60, v4
v_mul_u32_u24 v50, 336, v3
v_lshlrev_b32 v51, 2, v2
v_add_u32 v50, v50, v51
v_mov_b32 v52, 0x80000000
v_cmp_gt_u32 vcc, 5, v2
s_nop 1
v_cndmask_b32 v52, v52, v50, vcc
s_sub_u32 s70, 8, s60
s_cmp_eq_u32 s60, 0
s_cselect_b32 s70, 4, s70
s_lshl_b32 s71, s60, 8
s_add_u32 s71, s71, s3
s_mul_i32 s71, s71, 1344
s_sub_u32 s72, s70, s60
s_mul_i32 s72, s72, 344064
s_cmp_eq_u32 s60, 0
s_cselect_b32 s73, 0, s72
s_cselect_b32 s74, s72, 0
v_cmp_le_u32 vcc, 32, v1
v_mov_b32 v53, s73
s_nop 0
v_cndmask_b32 v53, 0, v53, vcc
v_mov_b32 v54, s73
v_cndmask_b32 v54, v54, 0, vcc
v_add_u32 v54, s74, v54
v_add_u32 v55, v50, v53
v_add_u32 v47, v52, v53
v_add_u32 v48, v50, v54
v_add_u32 v49, v52, v54
buffer_load_dword v8, v55, s[44:47], s71 offen offset:0
buffer_load_dword v9, v55, s[44:47], s71 offen offset:84
buffer_load_dword v10, v55, s[44:47], s71 offen offset:168
buffer_load_dword v11, v55, s[44:47], s71 offen offset:252
buffer_load_dword v12, v47, s[44:47], s71 offen offset:64
buffer_load_dword v13, v47, s[44:47], s71 offen offset:148
buffer_load_dword v14, v47, s[44:47], s71 offen offset:232
buffer_load_dword v15, v47, s[44:47], s71 offen offset:316
buffer_load_dword v16, v48, s[44:47], s71 offen offset:0
buffer_load_dword v17, v48, s[44:47], s71 offen offset:84
buffer_load_dword v18, v48, s[44:47], s71 offen offset:168
buffer_load_dword v19, v48, s[44:47], s71 offen offset:252
buffer_load_dword v20, v49, s[44:47], s71 offen offset:64
buffer_load_dword v21, v49, s[44:47], s71 offen offset:148
buffer_load_dword v22, v49, s[44:47], s71 offen offset:232
buffer_load_dword v23, v49, s[44:47], s71 offen offset:316
v_cvt_f32_u32 v80, v2
v_lshlrev_b32 v81, 2, v3
v_cvt_f32_u32 v82, v81
v_mul_f32 v83, 0x3d800000, v80
v_mul_f32 v84, v82, v83
v_lshrrev_b32 v88, 5, v1
v_lshlrev_b32 v88, 31, v88
v_cos_f32 v86, v84
v_sin_f32 v87, v84
s_nop 0
v_cvt_pk_bf16_f32 v24, v86, -v87
v_cvt_pk_bf16_f32 v28, v87, v86
v_xor_b32 v24, v24, v88
v_xor_b32 v28, v28, v88
v_fmamk_f32 v85, v83, 0x3f800000, v84
v_cos_f32 v86, v85
v_sin_f32 v87, v85
s_nop 0
v_cvt_pk_bf16_f32 v25, v86, -v87
v_cvt_pk_bf16_f32 v29, v87, v86
v_xor_b32 v25, v25, v88
v_xor_b32 v29, v29, v88
v_fmamk_f32 v85, v83, 0x40000000, v84
v_cos_f32 v86, v85
v_sin_f32 v87, v85
s_nop 0
v_cvt_pk_bf16_f32 v26, v86, -v87
v_cvt_pk_bf16_f32 v30, v87, v86
v_xor_b32 v26, v26, v88
v_xor_b32 v30, v30, v88
v_fmamk_f32 v85, v83, 0x40400000, v84
v_cos_f32 v86, v85
v_sin_f32 v87, v85
s_nop 0
v_cvt_pk_bf16_f32 v27, v86, -v87
v_cvt_pk_bf16_f32 v31, v87, v86
v_xor_b32 v27, v27, v88
v_xor_b32 v31, v31, v88
v_cmp_eq_u32 s[82:83], 0, v3
v_cmp_ge_u32 s[84:85], 1, v3
v_mul_f32 v83, 0x3acccccd, v80
v_mov_b32 v84, v82
v_mul_f32 v84, v84, v83
v_cos_f32 v86, v84
v_sin_f32 v87, v84
v_mov_b32 v88, 0x35cccccd
v_mov_b32 v89, 0x354ccccd
v_cndmask_b32 v88, v88, v89, s[82:83]
v_mul_f32 v32, v86, v88
v_mul_f32 v36, v87, v88
v_fmamk_f32 v85, v83, 0x3f800000, v84
v_cos_f32 v86, v85
v_sin_f32 v87, v85
v_mov_b32 v88, 0x35cccccd
v_mul_f32 v33, v86, v88
v_mul_f32 v37, v87, v88
v_fmamk_f32 v85, v83, 0x40000000, v84
v_cos_f32 v86, v85
v_sin_f32 v87, v85
v_mov_b32 v88, 0x35cccccd
v_mul_f32 v34, v86, v88
v_mul_f32 v38, v87, v88
v_fmamk_f32 v85, v83, 0x40400000, v84
v_cos_f32 v86, v85
v_sin_f32 v87, v85
v_mov_b32 v88, 0x35cccccd
v_mul_f32 v35, v86, v88
v_mul_f32 v39, v87, v88
v_add_f32 v84, 0x41800000, v82
v_mul_f32 v84, v84, v83
v_cos_f32 v86, v84
v_sin_f32 v87, v84
v_mov_b32 v88, 0x35cccccd
v_mov_b32 v89, 0x354ccccd
v_cndmask_b32 v88, v89, v88, s[82:83]
v_cndmask_b32 v88, 0, v88, s[84:85]
v_mul_f32 v40, v86, v88
v_mul_f32 v44, v87, v88
v_fmamk_f32 v85, v83, 0x3f800000, v84
v_cos_f32 v86, v85
v_sin_f32 v87, v85
v_mov_b32 v88, 0x35cccccd
v_cndmask_b32 v88, 0, v88, s[82:83]
v_mul_f32 v41, v86, v88
v_mul_f32 v45, v87, v88
v_fmamk_f32 v85, v83, 0x40000000, v84
v_cos_f32 v86, v85
v_sin_f32 v87, v85
v_mov_b32 v88, 0x35cccccd
v_cndmask_b32 v88, 0, v88, s[82:83]
v_mul_f32 v42, v86, v88
v_mul_f32 v46, v87, v88
v_fmamk_f32 v85, v83, 0x40400000, v84
v_cos_f32 v86, v85
v_sin_f32 v87, v85
v_mov_b32 v88, 0x35cccccd
v_cndmask_b32 v88, 0, v88, s[82:83]
v_mul_f32 v43, v86, v88
v_mul_f32 v47, v87, v88
v_cmp_gt_u32 s[86:87], 8, v2
s_nop 3
s_and_b64 s[88:89], s[86:87], s[82:83]
s_and_b64 s[76:77], s[86:87], s[84:85]
v_mov_b32 v83, v80
v_mul_f32 v83, 0x3ccccccd, v83
v_mov_b32 v84, v82
v_mul_f32 v84, v84, v83
v_cos_f32 v86, v84
v_sin_f32 v87, v84
s_nop 0
v_cvt_pk_bf16_f32 v56, v86, -v87
v_fmamk_f32 v85, v83, 0x3f800000, v84
v_cos_f32 v86, v85
v_sin_f32 v87, v85
s_nop 0
v_cvt_pk_bf16_f32 v57, v86, -v87
v_fmamk_f32 v85, v83, 0x40000000, v84
v_cos_f32 v86, v85
v_sin_f32 v87, v85
s_nop 0
v_cvt_pk_bf16_f32 v58, v86, -v87
v_fmamk_f32 v85, v83, 0x40400000, v84
v_cos_f32 v86, v85
v_sin_f32 v87, v85
s_nop 0
v_cvt_pk_bf16_f32 v59, v86, -v87
v_add_f32 v84, 0x41800000, v82
v_mul_f32 v84, v84, v83
v_cos_f32 v86, v84
v_sin_f32 v87, v84
s_nop 0
v_cvt_pk_bf16_f32 v60, v86, -v87
v_cndmask_b32 v60, 0, v60, s[84:85]
v_fmamk_f32 v85, v83, 0x3f800000, v84
v_cos_f32 v86, v85
v_sin_f32 v87, v85
s_nop 0
v_cvt_pk_bf16_f32 v61, v86, -v87
v_cndmask_b32 v61, 0, v61, s[82:83]
v_fmamk_f32 v85, v83, 0x40000000, v84
v_cos_f32 v86, v85
v_sin_f32 v87, v85
s_nop 0
v_cvt_pk_bf16_f32 v62, v86, -v87
v_cndmask_b32 v62, 0, v62, s[82:83]
v_fmamk_f32 v85, v83, 0x40400000, v84
v_cos_f32 v86, v85
v_sin_f32 v87, v85
s_nop 0
v_cvt_pk_bf16_f32 v63, v86, -v87
v_cndmask_b32 v63, 0, v63, s[82:83]
v_add_f32 v83, 0x41800000, v80
v_mul_f32 v83, 0x3ccccccd, v83
v_mov_b32 v84, v82
v_mul_f32 v84, v84, v83
v_cos_f32 v86, v84
v_sin_f32 v87, v84
s_nop 0
v_cvt_pk_bf16_f32 v64, v86, -v87
v_fmamk_f32 v85, v83, 0x3f800000, v84
v_cos_f32 v86, v85
v_sin_f32 v87, v85
s_nop 0
v_cvt_pk_bf16_f32 v65, v86, -v87
v_fmamk_f32 v85, v83, 0x40000000, v84
v_cos_f32 v86, v85
v_sin_f32 v87, v85
s_nop 0
v_cvt_pk_bf16_f32 v66, v86, -v87
v_fmamk_f32 v85, v83, 0x40400000, v84
v_cos_f32 v86, v85
v_sin_f32 v87, v85
s_nop 0
v_cvt_pk_bf16_f32 v67, v86, -v87
v_add_f32 v84, 0x41800000, v82
v_mul_f32 v84, v84, v83
v_cos_f32 v86, v84
v_sin_f32 v87, v84
s_nop 0
v_cvt_pk_bf16_f32 v68, v86, -v87
v_cndmask_b32 v68, 0, v68, s[84:85]
v_fmamk_f32 v85, v83, 0x3f800000, v84
v_cos_f32 v86, v85
v_sin_f32 v87, v85
s_nop 0
v_cvt_pk_bf16_f32 v69, v86, -v87
v_cndmask_b32 v69, 0, v69, s[82:83]
v_fmamk_f32 v85, v83, 0x40000000, v84
v_cos_f32 v86, v85
v_sin_f32 v87, v85
s_nop 0
v_cvt_pk_bf16_f32 v70, v86, -v87
v_cndmask_b32 v70, 0, v70, s[82:83]
v_fmamk_f32 v85, v83, 0x40400000, v84
v_cos_f32 v86, v85
v_sin_f32 v87, v85
s_nop 0
v_cvt_pk_bf16_f32 v71, v86, -v87
v_cndmask_b32 v71, 0, v71, s[82:83]
v_add_f32 v83, 0x42000000, v80
v_mul_f32 v83, 0x3ccccccd, v83
v_mov_b32 v84, v82
v_mul_f32 v84, v84, v83
v_cos_f32 v86, v84
v_sin_f32 v87, v84
s_nop 0
v_cvt_pk_bf16_f32 v72, v86, -v87
v_cndmask_b32 v72, 0, v72, s[86:87]
v_fmamk_f32 v85, v83, 0x3f800000, v84
v_cos_f32 v86, v85
v_sin_f32 v87, v85
s_nop 0
v_cvt_pk_bf16_f32 v73, v86, -v87
v_cndmask_b32 v73, 0, v73, s[86:87]
v_fmamk_f32 v85, v83, 0x40000000, v84
v_cos_f32 v86, v85
v_sin_f32 v87, v85
s_nop 0
v_cvt_pk_bf16_f32 v74, v86, -v87
v_cndmask_b32 v74, 0, v74, s[86:87]
v_fmamk_f32 v85, v83, 0x40400000, v84
v_cos_f32 v86, v85
v_sin_f32 v87, v85
s_nop 0
v_cvt_pk_bf16_f32 v75, v86, -v87
v_cndmask_b32 v75, 0, v75, s[86:87]
v_add_f32 v84, 0x41800000, v82
v_mul_f32 v84, v84, v83
v_cos_f32 v86, v84
v_sin_f32 v87, v84
s_nop 0
v_cvt_pk_bf16_f32 v76, v86, -v87
v_cndmask_b32 v76, 0, v76, s[76:77]
v_fmamk_f32 v85, v83, 0x3f800000, v84
v_cos_f32 v86, v85
v_sin_f32 v87, v85
s_nop 0
v_cvt_pk_bf16_f32 v77, v86, -v87
v_cndmask_b32 v77, 0, v77, s[88:89]
v_fmamk_f32 v85, v83, 0x40000000, v84
v_cos_f32 v86, v85
v_sin_f32 v87, v85
s_nop 0
v_cvt_pk_bf16_f32 v78, v86, -v87
v_cndmask_b32 v78, 0, v78, s[88:89]
v_fmamk_f32 v85, v83, 0x40400000, v84
v_cos_f32 v86, v85
v_sin_f32 v87, v85
s_nop 0
v_cvt_pk_bf16_f32 v79, v86, -v87
v_cndmask_b32 v79, 0, v79, s[88:89]
s_waitcnt vmcnt(12)
v_mfma_f32_16x16x32_bf16 v[80:83], v[8:11], v[24:27], 0
v_mfma_f32_16x16x32_bf16 v[84:87], v[8:11], v[28:31], 0
s_waitcnt vmcnt(8)
v_mfma_f32_16x16x32_bf16 v[88:91], v[12:15], v[24:27], 0
v_mfma_f32_16x16x32_bf16 v[92:95], v[12:15], v[28:31], 0
s_waitcnt vmcnt(4)
v_mfma_f32_16x16x32_bf16 v[96:99], v[16:19], v[24:27], 0
v_mfma_f32_16x16x32_bf16 v[100:103], v[16:19], v[28:31], 0
s_waitcnt vmcnt(0)
v_mfma_f32_16x16x32_bf16 v[104:107], v[20:23], v[24:27], 0
v_mfma_f32_16x16x32_bf16 v[108:111], v[20:23], v[28:31], 0
s_cmp_eq_u32 s60, 0
s_nop 6
s_cbranch_scc1 P3_W0
v_pk_add_f32 v[112:113], v[84:85], v[100:101] neg_lo:[0,1] neg_hi:[0,1]
v_pk_add_f32 v[84:85], v[84:85], v[100:101]
v_pk_add_f32 v[100:101], v[96:97], v[80:81] neg_lo:[0,1] neg_hi:[0,1]
v_pk_add_f32 v[80:81], v[80:81], v[96:97]
v_pk_mov_b32 v[96:97], v[112:113], v[112:113] op_sel:[0,1]
v_pk_add_f32 v[112:113], v[86:87], v[102:103] neg_lo:[0,1] neg_hi:[0,1]
v_pk_add_f32 v[86:87], v[86:87], v[102:103]
v_pk_add_f32 v[102:103], v[98:99], v[82:83] neg_lo:[0,1] neg_hi:[0,1]
v_pk_add_f32 v[82:83], v[82:83], v[98:99]
v_pk_mov_b32 v[98:99], v[112:113], v[112:113] op_sel:[0,1]
v_pk_add_f32 v[112:113], v[92:93], v[108:109] neg_lo:[0,1] neg_hi:[0,1]
v_pk_add_f32 v[92:93], v[92:93], v[108:109]
v_pk_add_f32 v[108:109], v[104:105], v[88:89] neg_lo:[0,1] neg_hi:[0,1]
v_pk_add_f32 v[88:89], v[88:89], v[104:105]
v_pk_mov_b32 v[104:105], v[112:113], v[112:113] op_sel:[0,1]
v_pk_add_f32 v[112:113], v[94:95], v[110:111] neg_lo:[0,1] neg_hi:[0,1]
v_pk_add_f32 v[94:95], v[94:95], v[110:111]
v_pk_add_f32 v[110:111], v[106:107], v[90:91] neg_lo:[0,1] neg_hi:[0,1]
v_pk_add_f32 v[90:91], v[90:91], v[106:107]
v_pk_mov_b32 v[106:107], v[112:113], v[112:113] op_sel:[0,1]
s_nop 1
P3_W0:
v_pk_mul_f32 v[112:113], v[80:81], v[32:33]
v_pk_mul_f32 v[114:115], v[84:85], v[32:33]
v_pk_fma_f32 v[112:113], v[84:85], v[36:37], v[112:113] neg_lo:[1,0,0] neg_hi:[1,0,0]
v_pk_fma_f32 v[114:115], v[80:81], v[36:37], v[114:115]
v_mul_u32_u24 v50, 80, v2
v_cvt_pk_bf16_f32 v8, v112, v114
v_cvt_pk_bf16_f32 v9, v113, v115
v_pk_mul_f32 v[112:113], v[82:83], v[34:35]
v_pk_mul_f32 v[114:115], v[86:87], v[34:35]
v_pk_fma_f32 v[112:113], v[86:87], v[38:39], v[112:113] neg_lo:[1,0,0] neg_hi:[1,0,0]
v_pk_fma_f32 v[114:115], v[82:83], v[38:39], v[114:115]
v_lshlrev_b32 v51, 4, v3
v_cvt_pk_bf16_f32 v10, v112, v114
v_cvt_pk_bf16_f32 v11, v113, v115
v_pk_mul_f32 v[112:113], v[88:89], v[40:41]
v_pk_mul_f32 v[114:115], v[92:93], v[40:41]
v_mfma_f32_16x16x32_bf16 v[80:83], v[8:11], v[56:59], 0
v_pk_fma_f32 v[112:113], v[92:93], v[44:45], v[112:113] neg_lo:[1,0,0] neg_hi:[1,0,0]
v_pk_fma_f32 v[114:115], v[88:89], v[44:45], v[114:115]
v_mfma_f32_16x16x32_bf16 v[84:87], v[8:11], v[64:67], 0
v_cvt_pk_bf16_f32 v12, v112, v114
v_cvt_pk_bf16_f32 v13, v113, v115
v_pk_mul_f32 v[112:113], v[90:91], v[42:43]
v_pk_mul_f32 v[114:115], v[94:95], v[42:43]
v_pk_fma_f32 v[112:113], v[94:95], v[46:47], v[112:113] neg_lo:[1,0,0] neg_hi:[1,0,0]
v_pk_fma_f32 v[114:115], v[90:91], v[46:47], v[114:115]
v_mfma_f32_16x16x32_bf16 v[88:91], v[8:11], v[72:75], 0
v_cvt_pk_bf16_f32 v14, v112, v114
v_cvt_pk_bf16_f32 v15, v113, v115
v_pk_mul_f32 v[112:113], v[96:97], v[32:33]
v_pk_mul_f32 v[114:115], v[100:101], v[32:33]
v_mfma_f32_16x16x32_bf16 v[80:83], v[12:15], v[60:63], v[80:83]
v_pk_fma_f32 v[112:113], v[100:101], v[36:37], v[112:113] neg_lo:[1,0,0] neg_hi:[1,0,0]
v_pk_fma_f32 v[114:115], v[96:97], v[36:37], v[114:115]
v_mfma_f32_16x16x32_bf16 v[84:87], v[12:15], v[68:71], v[84:87]
v_cvt_pk_bf16_f32 v16, v112, v114
v_cvt_pk_bf16_f32 v17, v113, v115
v_mfma_f32_16x16x32_bf16 v[88:91], v[12:15], v[76:79], v[88:91]
v_pk_mul_f32 v[112:113], v[98:99], v[34:35]
v_pk_mul_f32 v[114:115], v[102:103], v[34:35]
v_pk_fma_f32 v[112:113], v[102:103], v[38:39], v[112:113] neg_lo:[1,0,0] neg_hi:[1,0,0]
v_pk_fma_f32 v[114:115], v[98:99], v[38:39], v[114:115]
s_mul_i32 s73, s60, 7680
v_cvt_pk_bf16_f32 v18, v112, v114
v_cvt_pk_bf16_f32 v19, v113, v115
v_pk_mul_f32 v[112:113], v[104:105], v[40:41]
v_pk_mul_f32 v[114:115], v[108:109], v[40:41]
v_mfma_f32_16x16x32_bf16 v[92:95], v[16:19], v[56:59], 0
v_pk_fma_f32 v[112:113], v[108:109], v[44:45], v[112:113] neg_lo:[1,0,0] neg_hi:[1,0,0]
v_pk_fma_f32 v[114:115], v[104:105], v[44:45], v[114:115]
v_mfma_f32_16x16x32_bf16 v[96:99], v[16:19], v[64:67], 0
v_cvt_pk_bf16_f32 v20, v112, v114
v_cvt_pk_bf16_f32 v21, v113, v115
v_mfma_f32_16x16x32_bf16 v[100:103], v[16:19], v[72:75], 0
v_pk_mul_f32 v[112:113], v[106:107], v[42:43]
v_pk_mul_f32 v[114:115], v[110:111], v[42:43]
v_pk_fma_f32 v[112:113], v[110:111], v[46:47], v[112:113] neg_lo:[1,0,0] neg_hi:[1,0,0]
v_pk_fma_f32 v[114:115], v[106:107], v[46:47], v[114:115]
v_add_u32 v50, v50, v51
v_cvt_pk_bf16_f32 v22, v112, v114
v_cvt_pk_bf16_f32 v23, v113, v115
v_add_u32 v50, s73, v50
ds_write_b128 v50, v[80:83] offset:0
v_mfma_f32_16x16x32_bf16 v[92:95], v[20:23], v[60:63], v[92:95]
ds_write_b128 v50, v[84:87] offset:1280
ds_write_b128 v50, v[88:91] offset:2560
v_mfma_f32_16x16x32_bf16 v[96:99], v[20:23], v[68:71], v[96:99]
v_mfma_f32_16x16x32_bf16 v[100:103], v[20:23], v[76:79], v[100:103]
ds_write_b128 v50, v[92:95] offset:3840
s_nop 2
ds_write_b128 v50, v[96:99] offset:5120
s_nop 2
ds_write_b128 v50, v[100:103] offset:6400
s_waitcnt lgkmcnt(0)
s_barrier
v_lshrrev_b32 v51, 2, v0
v_and_b32 v52, 3, v0
v_mul_u32_u24 v51, 80, v51
v_lshlrev_b32 v52, 4, v52
s_mov_b32 s76, 0x3f3504f3
v_add_u32 v51, v51, v52
s_mov_b32 s77, 0x3f3504f3
ds_read_b128 v[8:11], v51 offset:0
ds_read_b128 v[12:15], v51 offset:3840
ds_read_b128 v[16:19], v51 offset:7680
ds_read_b128 v[20:23], v51 offset:11520
ds_read_b128 v[32:35], v51 offset:23040
ds_read_b128 v[36:39], v51 offset:26880
ds_read_b128 v[24:27], v51 offset:15360
ds_read_b128 v[28:31], v51 offset:19200
s_waitcnt lgkmcnt(6)
v_pk_add_f32 v[40:41], v[8:9], v[12:13]
v_pk_add_f32 v[42:43], v[8:9], v[12:13] neg_lo:[0,1] neg_hi:[0,1]
s_waitcnt lgkmcnt(3)
v_pk_add_f32 v[56:57], v[16:17], v[32:33] neg_lo:[0,1] neg_hi:[0,1]
v_pk_add_f32 v[52:53], v[16:17], v[32:33]
s_waitcnt lgkmcnt(2)
v_pk_add_f32 v[58:59], v[20:21], v[36:37]
v_pk_add_f32 v[54:55], v[36:37], v[20:21] neg_lo:[0,1] neg_hi:[0,1]
v_pk_add_f32 v[60:61], v[56:57], v[58:59] neg_lo:[0,1] neg_hi:[0,1]
v_pk_add_f32 v[62:63], v[56:57], v[58:59]
s_waitcnt lgkmcnt(1)
v_pk_add_f32 v[44:45], v[40:41], v[24:25]
v_pk_add_f32 v[46:47], v[40:41], v[24:25] neg_lo:[0,1] neg_hi:[0,1]
v_pk_add_f32 v[40:41], v[10:11], v[14:15]
v_pk_add_f32 v[56:57], v[18:19], v[34:35] neg_lo:[0,1] neg_hi:[0,1]
s_waitcnt lgkmcnt(0)
v_pk_add_f32 v[48:49], v[42:43], v[28:29] neg_lo:[0,1] neg_hi:[0,1]
v_pk_add_f32 v[50:51], v[42:43], v[28:29]
v_pk_add_f32 v[42:43], v[10:11], v[14:15] neg_lo:[0,1] neg_hi:[0,1]
v_pk_add_f32 v[58:59], v[22:23], v[38:39]
v_pk_add_f32 v[80:81], v[44:45], v[52:53]
v_pk_add_f32 v[88:89], v[44:45], v[52:53] neg_lo:[0,1] neg_hi:[0,1]
v_pk_add_f32 v[84:85], v[46:47], v[54:55]
v_pk_add_f32 v[92:93], v[46:47], v[54:55] neg_lo:[0,1] neg_hi:[0,1]
v_pk_fma_f32 v[82:83], v[60:61], s[76:77], v[48:49]
v_pk_fma_f32 v[90:91], v[60:61], s[76:77], v[48:49] neg_lo:[1,0,0] neg_hi:[1,0,0]
v_pk_fma_f32 v[86:87], v[62:63], s[76:77], v[50:51] neg_lo:[1,0,0] neg_hi:[1,0,0]
v_pk_fma_f32 v[94:95], v[62:63], s[76:77], v[50:51]
v_pk_add_f32 v[44:45], v[40:41], v[26:27]
v_pk_add_f32 v[46:47], v[40:41], v[26:27] neg_lo:[0,1] neg_hi:[0,1]
v_pk_add_f32 v[48:49], v[42:43], v[30:31] neg_lo:[0,1] neg_hi:[0,1]
v_pk_add_f32 v[50:51], v[42:43], v[30:31]
v_pk_add_f32 v[52:53], v[18:19], v[34:35]
v_pk_add_f32 v[54:55], v[38:39], v[22:23] neg_lo:[0,1] neg_hi:[0,1]
v_pk_add_f32 v[60:61], v[56:57], v[58:59] neg_lo:[0,1] neg_hi:[0,1]
v_pk_add_f32 v[62:63], v[56:57], v[58:59]
v_cvt_pk_bf16_f32 v64, v80, v81
v_cvt_pk_bf16_f32 v66, v82, v83
v_cvt_pk_bf16_f32 v68, v84, v85
v_cvt_pk_bf16_f32 v70, v86, v87
v_cvt_pk_bf16_f32 v72, v88, v89
v_cvt_pk_bf16_f32 v74, v90, v91
v_cvt_pk_bf16_f32 v76, v92, v93
v_cvt_pk_bf16_f32 v78, v94, v95
v_pk_add_f32 v[80:81], v[44:45], v[52:53]
v_pk_add_f32 v[88:89], v[44:45], v[52:53] neg_lo:[0,1] neg_hi:[0,1]
v_pk_add_f32 v[84:85], v[46:47], v[54:55]
v_pk_add_f32 v[92:93], v[46:47], v[54:55] neg_lo:[0,1] neg_hi:[0,1]
v_pk_fma_f32 v[82:83], v[60:61], s[76:77], v[48:49]
v_pk_fma_f32 v[90:91], v[60:61], s[76:77], v[48:49] neg_lo:[1,0,0] neg_hi:[1,0,0]
v_pk_fma_f32 v[86:87], v[62:63], s[76:77], v[50:51] neg_lo:[1,0,0] neg_hi:[1,0,0]
v_pk_fma_f32 v[94:95], v[62:63], s[76:77], v[50:51]
v_cvt_pk_bf16_f32 v65, v80, v81
v_cvt_pk_bf16_f32 v67, v82, v83
v_cvt_pk_bf16_f32 v69, v84, v85
v_cvt_pk_bf16_f32 v71, v86, v87
v_cvt_pk_bf16_f32 v73, v88, v89
v_cvt_pk_bf16_f32 v75, v90, v91
v_cvt_pk_bf16_f32 v77, v92, v93
v_cvt_pk_bf16_f32 v79, v94, v95
s_lshl_b32 s73, s60, 12
v_lshlrev_b32 v5, 3, v1
s_add_u32 s73, s73, 32768
v_lshlrev_b32 v6, 4, v1
v_add_u32 v5, s73, v5
v_add_u32 v6, s73, v6
ds_write_b64 v5, v[64:65] offset:0
ds_write_b64 v5, v[66:67] offset:512
ds_write_b64 v5, v[68:69] offset:1024
s_lshl_b32 s74, s60, 9
s_mul_i32 s61, s3, 2560
s_add_u32 s61, s61, 1280
ds_write_b64 v5, v[70:71] offset:1536
ds_write_b64 v5, v[72:73] offset:2048
ds_write_b64 v5, v[74:75] offset:2560
ds_write_b64 v5, v[76:77] offset:3072
ds_write_b64 v5, v[78:79] offset:3584
v_and_b32 v5, 31, v1
v_lshlrev_b32 v5, 4, v5
v_add_u32 v5, s74, v5
v_cmp_gt_u32 vcc, 1280, v5
ds_read_b128 v[8:11], v6 offset:0
ds_read_b128 v[12:15], v6 offset:1024
ds_read_b128 v[16:19], v6 offset:2048
ds_read_b128 v[20:23], v6 offset:3072
v_lshrrev_b32 v6, 5, v1
v_mul_u32_u24 v6, 655360, v6
v_add_u32 v5, v5, v6
v_mov_b32 v6, 0x80000000
v_cndmask_b32 v5, v6, v5, vcc
s_waitcnt lgkmcnt(3)
buffer_store_dwordx4 v[8:11], v5, s[48:51], s61 offen sc1
s_add_u32 s61, s61, 1310720
s_waitcnt lgkmcnt(2)
buffer_store_dwordx4 v[12:15], v5, s[48:51], s61 offen sc1
s_add_u32 s61, s61, 1310720
s_waitcnt lgkmcnt(1)
buffer_store_dwordx4 v[16:19], v5, s[48:51], s61 offen sc1
s_add_u32 s61, s61, 1310720
s_waitcnt lgkmcnt(0)
buffer_store_dwordx4 v[20:23], v5, s[48:51], s61 offen sc1
s_endpgm
s_nop 0
k3_kernel_YT:
s_sub_u32 s3, s2, 256
s_add_u32 s44, s40, 0x600000
s_addc_u32 s45, s41, 0
s_and_b32 s45, s45, 0xffff
s_mov_b32 s46, 0x280000
s_mov_b32 s47, 0x20000
s_mov_b32 s48, s36
s_mov_b32 s49, s37
s_and_b32 s49, s49, 0xffff
s_mov_b32 s50, 0x500000
s_mov_b32 s51, 0x20000
v_lshrrev_b32 v1, 3, v0
v_and_b32 v2, 7, v0
v_mul_u32_u24 v3, 8192, v1
v_lshlrev_b32 v4, 4, v2
v_add_u32 v3, v3, v4
s_mul_i32 s60, s3, 2
s_mul_hi_u32 s52, s60, 0x1999999a
s_mul_i32 s53, s52, 10
s_sub_u32 s53, s60, s53
s_mul_i32 s54, s53, 262144
s_lshl_b32 s55, s52, 7
s_add_u32 s54, s54, s55
s_mul_i32 s62, s52, 163840
s_lshl_b32 s55, s53, 7
s_add_u32 s62, s62, s55
buffer_load_dwordx4 v[8:11], v3, s[44:47], s54 offen
s_add_u32 s57, s54, 4096
buffer_load_dwordx4 v[12:15], v3, s[44:47], s57 offen
s_mul_i32 s60, s3, 2
s_add_u32 s60, s60, 1
s_mul_hi_u32 s52, s60, 0x1999999a
s_mul_i32 s53, s52, 10
s_sub_u32 s53, s60, s53
s_mul_i32 s54, s53, 262144
s_lshl_b32 s55, s52, 7
s_add_u32 s54, s54, s55
s_mul_i32 s63, s52, 163840
s_lshl_b32 s55, s53, 7
s_add_u32 s63, s63, s55
buffer_load_dwordx4 v[16:19], v3, s[44:47], s54 offen
s_add_u32 s57, s54, 4096
buffer_load_dwordx4 v[20:23], v3, s[44:47], s57 offen
v_lshrrev_b32 v4, 2, v1
v_xor_b32 v4, v4, v2
v_lshlrev_b32 v4, 4, v4
v_and_b32 v5, 3, v1
v_lshlrev_b32 v5, 2, v5
v_add_u32 v4, v4, v5
v_lshlrev_b32 v5, 10, v2
v_add_u32 v4, v4, v5
v_lshrrev_b32 v5, 3, v1
v_xor_b32 v6, v5, v2
v_lshlrev_b32 v6, 4, v6
v_lshlrev_b32 v7, 7, v1
v_add_u32 v6, v6, v7
v_add_u32 v5, 4, v5
v_xor_b32 v5, v5, v2
v_lshlrev_b32 v5, 4, v5
v_add_u32 v5, v5, v7
v_mul_u32_u24 v7, 2560, v1
v_lshlrev_b32 v24, 4, v2
v_add_u32 v7, v7, v24
s_mov_b32 s58, 0x05040100
s_mov_b32 s59, 0x07060302
s_waitcnt vmcnt(2)
v_perm_b32 v24, v12, v8, s58
v_perm_b32 v25, v12, v8, s59
v_perm_b32 v26, v13, v9, s58
v_perm_b32 v27, v13, v9, s59
v_perm_b32 v28, v14, v10, s58
v_perm_b32 v29, v14, v10, s59
v_perm_b32 v30, v15, v11, s58
v_perm_b32 v31, v15, v11, s59
ds_write_b32 v4, v24 offset:0
ds_write_b32 v4, v25 offset:128
ds_write_b32 v4, v26 offset:256
ds_write_b32 v4, v27 offset:384
ds_write_b32 v4, v28 offset:512
ds_write_b32 v4, v29 offset:640
ds_write_b32 v4, v30 offset:768
ds_write_b32 v4, v31 offset:896
s_waitcnt vmcnt(0)
v_perm_b32 v24, v20, v16, s58
v_perm_b32 v25, v20, v16, s59
v_perm_b32 v26, v21, v17, s58
v_perm_b32 v27, v21, v17, s59
v_perm_b32 v28, v22, v18, s58
v_perm_b32 v29, v22, v18, s59
v_perm_b32 v30, v23, v19, s58
v_perm_b32 v31, v23, v19, s59
ds_write_b32 v4, v24 offset:8192
ds_write_b32 v4, v25 offset:8320
ds_write_b32 v4, v26 offset:8448
ds_write_b32 v4, v27 offset:8576
ds_write_b32 v4, v28 offset:8704
ds_write_b32 v4, v29 offset:8832
ds_write_b32 v4, v30 offset:8960
ds_write_b32 v4, v31 offset:9088
s_waitcnt lgkmcnt(0)
s_barrier
ds_read_b128 v[8:11], v6 offset:0
ds_read_b128 v[12:15], v5 offset:4096
ds_read_b128 v[16:19], v6 offset:8192
ds_read_b128 v[20:23], v5 offset:12288
s_add_u32 s57, s62, 81920
s_waitcnt lgkmcnt(3)
buffer_store_dwordx4 v[8:11], v7, s[48:51], s62 offen sc1
s_waitcnt lgkmcnt(2)
buffer_store_dwordx4 v[12:15], v7, s[48:51], s57 offen sc1
s_add_u32 s57, s63, 81920
s_waitcnt lgkmcnt(1)
buffer_store_dwordx4 v[16:19], v7, s[48:51], s63 offen sc1
s_waitcnt lgkmcnt(0)
buffer_store_dwordx4 v[20:23], v7, s[48:51], s57 offen sc1
s_endpgm
.section .rodata,"a"
.p2align 6
.amdhsa_kernel k1_kernel
  .amdhsa_next_free_vgpr 128
  .amdhsa_next_free_sgpr 102
  .amdhsa_accum_offset 128
  .amdhsa_group_segment_fixed_size 0
  .amdhsa_kernarg_size 104
  .amdhsa_user_sgpr_count 2
  .amdhsa_user_sgpr_kernarg_segment_ptr 1
  .amdhsa_system_sgpr_workgroup_id_x 1
.end_amdhsa_kernel
.p2align 6
.amdhsa_kernel k2_kernel
  .amdhsa_next_free_vgpr 232
  .amdhsa_next_free_sgpr 102
  .amdhsa_accum_offset 232
  .amdhsa_group_segment_fixed_size 0
  .amdhsa_kernarg_size 104
  .amdhsa_user_sgpr_count 2
  .amdhsa_user_sgpr_kernarg_segment_ptr 1
  .amdhsa_system_sgpr_workgroup_id_x 1
.end_amdhsa_kernel
.p2align 6
.amdhsa_kernel k3_kernel
  .amdhsa_next_free_vgpr 128
  .amdhsa_next_free_sgpr 102
  .amdhsa_accum_offset 128
  .amdhsa_group_segment_fixed_size 0
  .amdhsa_kernarg_size 104
  .amdhsa_user_sgpr_count 2
  .amdhsa_user_sgpr_kernarg_segment_ptr 1
  .amdhsa_system_sgpr_workgroup_id_x 1
.end_amdhsa_kernel
```
